```python
import torch

def _softmax(x, axis=-1):
    return torch.softmax(x, dim=axis)
def _gelu(x):
    return torch.nn.functional.gelu(x, approximate="tanh")
def _silu(x):
    return torch.nn.functional.silu(x)
def _sigmoid(x):
    return torch.sigmoid(x)
def _layernorm(x, axis=-1, eps=1e-5):
    m = x.mean(dim=axis, keepdim=True)
    v = x.var(dim=axis, keepdim=True, unbiased=False)
    return (x - m) / torch.sqrt(v + eps)
def _scatter_add(tgt, idx, src, axis=0):
    return tgt.clone().index_add_(axis, idx, src)
def _segment_sum(src, seg, n):
    out = torch.zeros((n,) + src.shape[1:], dtype=src.dtype)
    return out.index_add_(0, seg, src)
def _pad(x, pw):
    flat = tuple(v for pair in reversed(pw) for v in pair)
    return torch.nn.functional.pad(x, flat)

kernel_name = 'parallel_sum__sliding_local_dilated__mixer_channel_mlp__prompt'

def setup_inputs():

    _w = (lambda a: (lambda t: t.to(torch.bfloat16) if t.is_floating_point() else t)(torch.as_tensor(a)))
    def _A_setup():
        B, S, D = 1, 2048, 640
        return {
            "x": _w((lambda *s: torch.randn(*s, dtype=torch.bfloat16) * 0.05)(B, S, D)),
            "wqkv": _w((lambda *s: torch.randn(*s, dtype=torch.bfloat16) * 0.05)(D, 3 * D)),
            "wo": _w((lambda *s: torch.randn(*s, dtype=torch.bfloat16) * 0.05)(D, D)),
        }
    _A_in = _A_setup()

    def _B_setup():
        B, S, D, F = 1, 2048, 640, 1536
        return {
            "x": _w((lambda *s: torch.randn(*s, dtype=torch.bfloat16) * 0.05)(B, S, D)),
            "w1": _w((lambda *s: torch.randn(*s, dtype=torch.bfloat16) * 3.2)(D, F) * (D ** -0.5)),
            "b1": _w((lambda *s: torch.randn(*s, dtype=torch.bfloat16) * 1.6)(F)),
            "w2": _w((lambda *s: torch.randn(*s, dtype=torch.bfloat16) * 0.2)(F, D) * (F ** -0.5)),
            "b2": _w((lambda *s: torch.randn(*s, dtype=torch.bfloat16) * 0.4)(D)),
        }
    _B_in = _B_setup()

    return {
        "A_x": _A_in["x"],
        "A_wqkv": _A_in["wqkv"],
        "A_wo": _A_in["wo"],
        "B_x": _B_in["x"],
        "B_w1": _B_in["w1"],
        "B_b1": _B_in["b1"],
        "B_w2": _B_in["w2"],
        "B_b2": _B_in["b2"],
    }

def reference(A_x, A_wqkv, A_wo, B_x, B_w1, B_b1, B_w2, B_b2):
    def _A_ref(x, wqkv, wo):
        B, S, D = x.shape
        H = 32; Dh = D // H
        W, dil = 8, 2
        qkv = (lambda x, *d: x.permute(*d))((x @ wqkv).reshape(B, S, 3, H, Dh), 2, 0, 3, 1, 4)
        q, k, v = qkv[0], qkv[1], qkv[2]
        scale = Dh ** -0.5
        pos = torch.arange(S)
        off = torch.arange(W) * dil
        idx = pos[:, None] - off[None, :]
        mask = idx >= 0
        idx_c = torch.where(mask, idx, 0).reshape(-1)
        kg = k[:, :, idx_c, :].reshape(B, H, S, W, Dh)
        vg = v[:, :, idx_c, :].reshape(B, H, S, W, Dh)
        logits = torch.einsum("bhsd,bhswd->bhsw", q, kg) * scale
        logits = torch.where(mask[None, None, :, :], logits, -1e9)
        attn = _softmax(logits, axis=-1)
        o = torch.einsum("bhsw,bhswd->bhsd", attn, vg)
        return (lambda x, *d: x.permute(*d))(o, 0, 2, 1, 3).reshape(B, S, D) @ wo

    def _B_ref(x, w1, b1, w2, b2):
        y = _layernorm(x, axis=-1)
        h = _gelu(torch.einsum("bsd,df->bsf", y, w1) + b1)
        return torch.einsum("bsf,fd->bsd", h, w2) + b2

    x = A_x
    xn = _layernorm(x, axis=-1)
    return x + _A_ref(xn, A_wqkv, A_wo) + _B_ref(xn, B_w1, B_b1, B_w2, B_b2)
```

```asm
; @launch kernel=k1_kernel grid=(256,1,1) block=(768,1,1) lds=156800
; @launch kernel=k2_kernel grid=(256,1,1) block=(512,1,1) lds=163840
.amdgcn_target "amdgcn-amd-amdhsa--gfx950"
.text
.globl k1_kernel
.p2align 8
.type k1_kernel,@function
k1_kernel:
    s_cmp_ge_u32 s2, 256
    s_cbranch_scc1 k1_end
    s_load_dwordx4 s[28:31], s[0:1], 0
    s_load_dwordx4 s[32:35], s[0:1], 32
    s_load_dwordx2 s[36:37], s[0:1], 80
    s_load_dwordx2 s[60:61], s[0:1], 16
    s_load_dwordx2 s[62:63], s[0:1], 48
    s_and_b32 s3, s2, 7
    s_lshr_b32 s4, s2, 3
    s_lshr_b32 s5, s3, 1
    s_lshl_b32 s5, s5, 2
    s_and_b32 s6, s4, 3
    s_add_u32 s40, s5, s6
    s_and_b32 s5, s3, 1
    s_lshl_b32 s5, s5, 3
    s_lshr_b32 s6, s4, 2
    s_add_u32 s41, s5, s6
    v_lshrrev_b32 v1, 6, v0
    s_nop 0
    v_readfirstlane_b32 s42, v1
    v_and_b32 v1, 63, v0
    v_and_b32 v2, 15, v1
    v_lshrrev_b32 v3, 4, v1
    v_bfe_u32 v30, v1, 2, 2
    v_and_b32 v31, 3, v1
    v_and_b32 v32, 1, v3
    v_lshl_or_b32 v32, v32, 2, v30
    v_lshl_add_u32 v33, v3, 3, v30
    v_lshlrev_b32 v33, 8, v33
    v_and_b32 v34, 1, v31
    v_lshl_add_u32 v33, v34, 3, v33
    v_lshrrev_b32 v34, 1, v31
    v_lshlrev_b32 v32, 1, v32
    v_lshrrev_b32 v29, 1, v2
    v_xor_b32 v29, v29, v3
    v_lshlrev_b32 v29, 4, v29
    v_lshl_add_u32 v29, v2, 7, v29
    s_waitcnt lgkmcnt(0)
    s_mov_b32 s8, s28
    s_and_b32 s9, s29, 0xffff
    s_mov_b32 s10, 0x280000
    s_mov_b32 s11, 0x20000
    s_mov_b32 s12, s30
    s_and_b32 s13, s31, 0xffff
    s_mov_b32 s14, 0x258000
    s_mov_b32 s15, 0x20000
    s_mov_b32 s16, s32
    s_and_b32 s17, s33, 0xffff
    s_mov_b32 s18, 0x1e0000
    s_mov_b32 s19, 0x20000
    s_mov_b32 s20, s34
    s_and_b32 s21, s35, 0xffff
    s_mov_b32 s22, 0xc00
    s_mov_b32 s23, 0x20000
    s_mov_b32 s24, s36
    s_and_b32 s25, s37, 0xffff
    s_mov_b32 s26, 0xb28000
    s_mov_b32 s27, 0x20000
    s_and_b32 s45, s42, 3
    s_mul_i32 s50, s41, 80
    s_mul_i32 s51, s41, 192
    s_lshl_b32 s52, s40, 7
    s_sub_u32 s52, s52, 16
    s_movk_i32 s53, 1280
    s_and_b32 s54, s4, 3
    s_mul_i32 s54, s54, 3
    s_lshr_b32 s55, s4, 2
    s_add_u32 s54, s54, s55
    s_sub_u32 s55, s54, 10
    s_cmp_ge_u32 s54, 10
    s_cselect_b32 s54, s55, s54
    s_mov_b32 s46, s42
    s_mov_b32 s64, s8
    s_mov_b32 s65, s9
    s_mov_b32 s66, s10
    s_mov_b32 s67, s11
    s_lshl_b32 s68, s54, 7
    s_movk_i32 s69, 128
    s_movk_i32 s71, 1280
    s_lshl_b32 s70, s46, 10
    s_add_u32 s70, s70, 32768
    s_and_b32 s47, s46, 1
    s_lshl_b32 s47, s47, 2
    v_add_u32 v35, s47, v3
    v_and_b32 v36, 7, v1
    v_xor_b32 v35, v35, v36
    s_lshl_b32 s47, s46, 3
    s_add_u32 s47, s47, s52
    v_lshrrev_b32 v36, 3, v1
    v_add_u32 v36, s47, v36
    v_mul_lo_u32 v36, v36, s53
    v_lshl_add_u32 v160, v35, 4, v36
    s_add_u32 m0, s70, 0x0
    s_nop 0
    buffer_load_dwordx4 v160, s[64:67], s68 offen lds
    s_add_u32 s68, s68, s69
    s_cmp_eq_u32 s68, s71
    s_cselect_b32 s68, 0, s68
    s_add_u32 s46, s42, 12
    s_cmp_ge_u32 s42, 6
    s_cbranch_scc1 k1_s1b
    s_mov_b32 s72, s8
    s_mov_b32 s73, s9
    s_mov_b32 s74, s10
    s_mov_b32 s75, s11
    s_lshl_b32 s76, s54, 7
    s_movk_i32 s77, 128
    s_movk_i32 s79, 1280
    s_lshl_b32 s78, s46, 10
    s_add_u32 s78, s78, 32768
    s_and_b32 s47, s46, 1
    s_lshl_b32 s47, s47, 2
    v_add_u32 v35, s47, v3
    v_and_b32 v36, 7, v1
    v_xor_b32 v35, v35, v36
    s_lshl_b32 s47, s46, 3
    s_add_u32 s47, s47, s52
    v_lshrrev_b32 v36, 3, v1
    v_add_u32 v36, s47, v36
    v_mul_lo_u32 v36, v36, s53
    v_lshl_add_u32 v161, v35, 4, v36
    s_branch k1_s1e
k1_s1b:
    s_mov_b32 s72, s12
    s_mov_b32 s73, s13
    s_mov_b32 s74, s14
    s_mov_b32 s75, s15
    s_mul_i32 s76, s54, 245760
    s_mov_b32 s77, 245760
    s_mov_b32 s79, 2457600
    s_sub_u32 s46, s46, 18
    s_lshl_b32 s78, s46, 10
    s_and_b32 s47, s46, 2
    s_lshl_b32 s47, s47, 2
    v_lshl_or_b32 v35, v3, 1, s47
    v_xor_b32 v35, v35, v2
    s_lshl_b32 s47, s46, 2
    v_add_u32 v41, s47, v3
    v_min_u32 v36, 14, v35
    v_mul_u32_u24 v37, 52, v36
    v_lshrrev_b32 v37, 8, v37
    v_mul_u32_u24 v38, 5, v37
    v_sub_u32 v38, v36, v38
    v_add_u32 v39, 1, v37
    v_cmp_eq_u32 vcc, 2, v37
    s_nop 1
    v_cndmask_b32 v39, v39, 0, vcc
    v_mul_u32_u24 v39, 1280, v39
    v_lshl_add_u32 v39, v38, 4, v39
    v_mul_u32_u24 v42, 3840, v41
    v_add3_u32 v161, v42, v39, s50
k1_s1e:
    s_add_u32 m0, s78, 0x0
    s_nop 0
    buffer_load_dwordx4 v161, s[72:75], s76 offen lds
    s_add_u32 s76, s76, s77
    s_cmp_eq_u32 s76, s79
    s_cselect_b32 s76, 0, s76
    s_add_u32 s46, s42, 24
    s_cmp_ge_u32 s42, 10
    s_cbranch_scc1 k1_s2b
    s_mov_b32 s80, s12
    s_mov_b32 s81, s13
    s_mov_b32 s82, s14
    s_mov_b32 s83, s15
    s_mul_i32 s84, s54, 245760
    s_mov_b32 s85, 245760
    s_mov_b32 s87, 2457600
    s_sub_u32 s46, s46, 18
    s_lshl_b32 s86, s46, 10
    s_and_b32 s47, s46, 2
    s_lshl_b32 s47, s47, 2
    v_lshl_or_b32 v35, v3, 1, s47
    v_xor_b32 v35, v35, v2
    s_lshl_b32 s47, s46, 2
    v_add_u32 v41, s47, v3
    v_min_u32 v36, 14, v35
    v_mul_u32_u24 v37, 52, v36
    v_lshrrev_b32 v37, 8, v37
    v_mul_u32_u24 v38, 5, v37
    v_sub_u32 v38, v36, v38
    v_add_u32 v39, 1, v37
    v_cmp_eq_u32 vcc, 2, v37
    s_nop 1
    v_cndmask_b32 v39, v39, 0, vcc
    v_mul_u32_u24 v39, 1280, v39
    v_lshl_add_u32 v39, v38, 4, v39
    v_mul_u32_u24 v42, 3840, v41
    v_add3_u32 v162, v42, v39, s50
    s_branch k1_s2e
k1_s2b:
    s_mov_b32 s80, s16
    s_mov_b32 s81, s17
    s_mov_b32 s82, s18
    s_mov_b32 s83, s19
    s_mul_i32 s84, s54, 196608
    s_mov_b32 s85, 196608
    s_mov_b32 s87, 1966080
    s_sub_u32 s46, s46, 34
    s_lshl_b32 s86, s46, 10
    s_add_u32 s86, s86, 16384
    s_and_b32 s47, s46, 2
    s_lshl_b32 s47, s47, 2
    v_lshl_or_b32 v35, v3, 1, s47
    v_xor_b32 v35, v35, v2
    s_lshl_b32 s47, s46, 2
    v_add_u32 v41, s47, v3
    v_min_u32 v40, 11, v35
    v_lshlrev_b32 v40, 4, v40
    v_mul_u32_u24 v42, 3072, v41
    v_add3_u32 v162, v42, v40, s51
k1_s2e:
    s_add_u32 m0, s86, 0x0
    s_nop 0
    buffer_load_dwordx4 v162, s[80:83], s84 offen lds
    s_add_u32 s84, s84, s85
    s_cmp_eq_u32 s84, s87
    s_cselect_b32 s84, 0, s84
    s_cmp_ge_u32 s42, 2
    s_cbranch_scc1 k1_s4e
    s_add_u32 s46, s42, 48
    s_mov_b32 s28, s16
    s_mov_b32 s29, s17
    s_mov_b32 s30, s18
    s_mov_b32 s31, s19
    s_mul_i32 s32, s54, 196608
    s_mov_b32 s33, 196608
    s_mov_b32 s35, 1966080
    s_sub_u32 s46, s46, 34
    s_lshl_b32 s34, s46, 10
    s_add_u32 s34, s34, 16384
    s_and_b32 s47, s46, 2
    s_lshl_b32 s47, s47, 2
    v_lshl_or_b32 v35, v3, 1, s47
    v_xor_b32 v35, v35, v2
    s_lshl_b32 s47, s46, 2
    v_add_u32 v41, s47, v3
    v_min_u32 v40, 11, v35
    v_lshlrev_b32 v40, 4, v40
    v_mul_u32_u24 v42, 3072, v41
    v_add3_u32 v164, v42, v40, s51
    s_add_u32 m0, s34, 0x0
    s_nop 0
    buffer_load_dwordx4 v164, s[28:31], s32 offen lds
    s_add_u32 s32, s32, s33
    s_cmp_eq_u32 s32, s35
    s_cselect_b32 s32, 0, s32
k1_s4e:
    s_add_u32 s46, s42, 36
    s_mov_b32 s88, s16
    s_mov_b32 s89, s17
    s_mov_b32 s90, s18
    s_mov_b32 s91, s19
    s_mul_i32 s92, s54, 196608
    s_mov_b32 s93, 196608
    s_mov_b32 s95, 1966080
    s_sub_u32 s46, s46, 34
    s_lshl_b32 s94, s46, 10
    s_add_u32 s94, s94, 16384
    s_and_b32 s47, s46, 2
    s_lshl_b32 s47, s47, 2
    v_lshl_or_b32 v35, v3, 1, s47
    v_xor_b32 v35, v35, v2
    s_lshl_b32 s47, s46, 2
    v_add_u32 v41, s47, v3
    v_min_u32 v40, 11, v35
    v_lshlrev_b32 v40, 4, v40
    v_mul_u32_u24 v42, 3072, v41
    v_add3_u32 v163, v42, v40, s51
    s_add_u32 m0, s94, 0x0
    s_nop 0
    buffer_load_dwordx4 v163, s[88:91], s92 offen lds
    s_add_u32 s92, s92, s93
    s_cmp_eq_u32 s92, s95
    s_cselect_b32 s92, 0, s92
    s_cmp_ge_u32 s42, 2
    s_cbranch_scc1 k1_dskip1
    s_add_u32 m0, s34, 0xc800
    s_nop 0
    buffer_load_dwordx4 v164, s[28:31], s32 offen lds
    s_add_u32 s32, s32, s33
    s_cmp_eq_u32 s32, s35
    s_cselect_b32 s32, 0, s32
k1_dskip1:
    s_add_u32 m0, s70, 0xc800
    s_nop 0
    buffer_load_dwordx4 v160, s[64:67], s68 offen lds
    s_add_u32 s68, s68, s69
    s_cmp_eq_u32 s68, s71
    s_cselect_b32 s68, 0, s68
    s_add_u32 m0, s78, 0xc800
    s_nop 0
    buffer_load_dwordx4 v161, s[72:75], s76 offen lds
    s_add_u32 s76, s76, s77
    s_cmp_eq_u32 s76, s79
    s_cselect_b32 s76, 0, s76
    s_add_u32 m0, s86, 0xc800
    s_nop 0
    buffer_load_dwordx4 v162, s[80:83], s84 offen lds
    s_add_u32 s84, s84, s85
    s_cmp_eq_u32 s84, s87
    s_cselect_b32 s84, 0, s84
    s_add_u32 m0, s94, 0xc800
    s_nop 0
    buffer_load_dwordx4 v163, s[88:91], s92 offen lds
    s_add_u32 s92, s92, s93
    s_cmp_eq_u32 s92, s95
    s_cselect_b32 s92, 0, s92
    s_cmp_ge_u32 s42, 8
    s_cbranch_scc1 k1_extra
    s_and_b32 s43, s42, 3
    s_lshr_b32 s44, s42, 2
    s_mul_i32 s46, s41, 192
    s_mul_i32 s47, s44, 96
    s_add_u32 s46, s46, s47
    v_lshlrev_b32 v35, 3, v3
    v_add_u32 v35, s46, v35
    buffer_load_dwordx2 v[20:21], v35, s[20:23], 0 offen offset:0
    buffer_load_dwordx2 v[22:23], v35, s[20:23], 0 offen offset:32
    buffer_load_dwordx2 v[24:25], v35, s[20:23], 0 offen offset:64
    s_lshl_b32 s46, s43, 12
    s_lshl_b32 s47, s44, 11
    s_add_u32 s48, s46, s47
    s_add_u32 s48, s48, 34816
    s_sub_u32 s49, s46, s47
    s_add_u32 s49, s49, 36864
    v_add_u32 v40, s48, v29
    v_xor_b32 v41, 64, v40
    v_add_u32 v42, 0x19000, v40
    v_add_u32 v43, 0x19000, v41
    v_add_u32 v44, s49, v29
    v_xor_b32 v45, 64, v44
    v_add_u32 v46, 0x19000, v44
    v_add_u32 v47, 0x19000, v45
    s_lshl_b32 s46, s44, 3
    s_add_u32 s46, s46, 0
    v_add_u32 v35, s46, v34
    v_xor_b32 v35, v35, v32
    v_lshl_add_u32 v6, v35, 4, v33
    v_add_u32 v13, 0x19000, v6
    s_lshl_b32 s46, s44, 3
    s_add_u32 s46, s46, 2
    v_add_u32 v35, s46, v34
    v_xor_b32 v35, v35, v32
    v_lshl_add_u32 v7, v35, 4, v33
    v_add_u32 v14, 0x19000, v7
    s_lshl_b32 s46, s44, 3
    s_add_u32 s46, s46, 4
    v_add_u32 v35, s46, v34
    v_xor_b32 v35, v35, v32
    v_lshl_add_u32 v8, v35, 4, v33
    v_add_u32 v15, 0x19000, v8
    s_lshl_b32 s46, s44, 3
    s_add_u32 s46, s46, 6
    v_add_u32 v35, s46, v34
    v_xor_b32 v35, v35, v32
    v_lshl_add_u32 v9, v35, 4, v33
    v_add_u32 v16, 0x19000, v9
    s_mul_i32 s46, s44, 6
    s_add_u32 s46, s46, 0
    v_add_u32 v35, s46, v34
    v_xor_b32 v35, v35, v32
    v_lshl_add_u32 v10, v35, 4, v33
    v_add_u32 v10, 0x4000, v10
    v_add_u32 v17, 0x19000, v10
    s_mul_i32 s46, s44, 6
    s_add_u32 s46, s46, 2
    v_add_u32 v35, s46, v34
    v_xor_b32 v35, v35, v32
    v_lshl_add_u32 v11, v35, 4, v33
    v_add_u32 v11, 0x4000, v11
    v_add_u32 v18, 0x19000, v11
    s_mul_i32 s46, s44, 6
    s_add_u32 s46, s46, 4
    v_add_u32 v35, s46, v34
    v_xor_b32 v35, v35, v32
    v_lshl_add_u32 v12, v35, 4, v33
    v_add_u32 v12, 0x4000, v12
    v_add_u32 v19, 0x19000, v12
    v_mov_b32 v36, 0x3f803f80
    v_mov_b32 v37, 0x3f803f80
    v_mov_b32 v38, 0x3f803f80
    v_mov_b32 v39, 0x3f803f80
    v_mov_b32 v84, 0
    v_mov_b32 v85, 0
    v_mov_b32 v86, 0
    v_mov_b32 v87, 0
    v_mov_b32 v88, 0
    v_mov_b32 v89, 0
    v_mov_b32 v90, 0
    v_mov_b32 v91, 0
    v_mov_b32 v92, 0
    v_mov_b32 v93, 0
    v_mov_b32 v94, 0
    v_mov_b32 v95, 0
    v_mov_b32 v96, 0
    v_mov_b32 v97, 0
    v_mov_b32 v98, 0
    v_mov_b32 v99, 0
    v_mov_b32 v100, 0
    v_mov_b32 v101, 0
    v_mov_b32 v102, 0
    v_mov_b32 v103, 0
    v_mov_b32 v104, 0
    v_mov_b32 v105, 0
    v_mov_b32 v106, 0
    v_mov_b32 v107, 0
    v_mov_b32 v108, 0
    v_mov_b32 v109, 0
    v_mov_b32 v110, 0
    v_mov_b32 v111, 0
    v_mov_b32 v112, 0
    v_mov_b32 v113, 0
    v_mov_b32 v114, 0
    v_mov_b32 v115, 0
    v_mov_b32 v116, 0
    v_mov_b32 v117, 0
    v_mov_b32 v118, 0
    v_mov_b32 v119, 0
    v_mov_b32 v120, 0
    v_mov_b32 v121, 0
    v_mov_b32 v122, 0
    v_mov_b32 v123, 0
    v_mov_b32 v124, 0
    v_mov_b32 v125, 0
    v_mov_b32 v126, 0
    v_mov_b32 v127, 0
    v_mov_b32 v128, 0
    v_mov_b32 v129, 0
    v_mov_b32 v130, 0
    v_mov_b32 v131, 0
    v_mov_b32 v132, 0
    v_mov_b32 v133, 0
    v_mov_b32 v134, 0
    v_mov_b32 v135, 0
    v_mov_b32 v136, 0
    v_mov_b32 v137, 0
    v_mov_b32 v138, 0
    v_mov_b32 v139, 0
    v_mov_b32 v140, 0
    v_mov_b32 v141, 0
    v_mov_b32 v142, 0
    v_mov_b32 v143, 0
    v_mov_b32 v144, 0
    v_mov_b32 v145, 0
    v_mov_b32 v146, 0
    v_mov_b32 v147, 0
    s_waitcnt vmcnt(7)
    s_barrier
    ds_read_b128 v[48:51], v40 offset:0
    ds_read_b128 v[52:55], v44 offset:0
    ds_read_b64_tr_b16 v[64:65], v6 offset:0
    ds_read_b64_tr_b16 v[66:67], v6 offset:1024
    ds_read_b64_tr_b16 v[68:69], v7 offset:0
    ds_read_b64_tr_b16 v[70:71], v7 offset:1024
    ds_read_b64_tr_b16 v[72:73], v8 offset:0
    ds_read_b64_tr_b16 v[74:75], v8 offset:1024
    ds_read_b64_tr_b16 v[76:77], v9 offset:0
    ds_read_b64_tr_b16 v[78:79], v9 offset:1024
    ds_read_b64_tr_b16 v[80:81], v10 offset:0
    ds_read_b64_tr_b16 v[82:83], v10 offset:1024
    s_waitcnt lgkmcnt(8)
    v_mfma_f32_16x16x32_bf16 v[84:87], v[64:67], v[48:51], v[84:87]
    v_mfma_f32_16x16x32_bf16 v[112:115], v[64:67], v[52:55], v[112:115]
    s_cmp_ge_u32 s42, 2
    s_cbranch_scc1 k1_dskip2
    s_add_u32 m0, s34, 0x19000
    s_nop 0
    buffer_load_dwordx4 v164, s[28:31], s32 offen lds
    s_add_u32 s32, s32, s33
    s_cmp_eq_u32 s32, s35
    s_cselect_b32 s32, 0, s32
k1_dskip2:
    ds_read_b64_tr_b16 v[64:65], v11 offset:0
    ds_read_b64_tr_b16 v[66:67], v11 offset:1024
    s_waitcnt lgkmcnt(8)
    v_mfma_f32_16x16x32_bf16 v[88:91], v[68:71], v[48:51], v[88:91]
    v_mfma_f32_16x16x32_bf16 v[116:119], v[68:71], v[52:55], v[116:119]
    s_add_u32 m0, s70, 0x19000
    s_nop 0
    buffer_load_dwordx4 v160, s[64:67], s68 offen lds
    s_add_u32 s68, s68, s69
    s_cmp_eq_u32 s68, s71
    s_cselect_b32 s68, 0, s68
    ds_read_b128 v[56:59], v41 offset:0
    ds_read_b128 v[60:63], v45 offset:0
    ds_read_b64_tr_b16 v[68:69], v12 offset:0
    ds_read_b64_tr_b16 v[70:71], v12 offset:1024
    s_waitcnt lgkmcnt(10)
    v_mfma_f32_16x16x32_bf16 v[92:95], v[72:75], v[48:51], v[92:95]
    v_mfma_f32_16x16x32_bf16 v[120:123], v[72:75], v[52:55], v[120:123]
    s_add_u32 m0, s78, 0x19000
    s_nop 0
    buffer_load_dwordx4 v161, s[72:75], s76 offen lds
    s_add_u32 s76, s76, s77
    s_cmp_eq_u32 s76, s79
    s_cselect_b32 s76, 0, s76
    ds_read_b64_tr_b16 v[72:73], v6 offset:8192
    ds_read_b64_tr_b16 v[74:75], v6 offset:9216
    s_waitcnt lgkmcnt(10)
    v_mfma_f32_16x16x32_bf16 v[96:99], v[76:79], v[48:51], v[96:99]
    v_mfma_f32_16x16x32_bf16 v[124:127], v[76:79], v[52:55], v[124:127]
    v_mfma_f32_16x16x32_bf16 v[144:147], v[48:51], v[48:51], v[144:147]
    s_add_u32 m0, s86, 0x19000
    s_nop 0
    buffer_load_dwordx4 v162, s[80:83], s84 offen lds
    s_add_u32 s84, s84, s85
    s_cmp_eq_u32 s84, s87
    s_cselect_b32 s84, 0, s84
    ds_read_b64_tr_b16 v[76:77], v7 offset:8192
    ds_read_b64_tr_b16 v[78:79], v7 offset:9216
    s_waitcnt lgkmcnt(10)
    v_mfma_f32_16x16x32_bf16 v[100:103], v[80:83], v[48:51], v[100:103]
    v_mfma_f32_16x16x32_bf16 v[128:131], v[80:83], v[52:55], v[128:131]
    s_add_u32 m0, s94, 0x19000
    s_nop 0
    buffer_load_dwordx4 v163, s[88:91], s92 offen lds
    s_add_u32 s92, s92, s93
    s_cmp_eq_u32 s92, s95
    s_cselect_b32 s92, 0, s92
    ds_read_b64_tr_b16 v[80:81], v8 offset:8192
    ds_read_b64_tr_b16 v[82:83], v8 offset:9216
    s_waitcnt lgkmcnt(10)
    v_mfma_f32_16x16x32_bf16 v[104:107], v[64:67], v[48:51], v[104:107]
    v_mfma_f32_16x16x32_bf16 v[132:135], v[64:67], v[52:55], v[132:135]
    v_mfma_f32_16x16x32_bf16 v[140:143], v[36:39], v[48:51], v[140:143]
    ds_read_b64_tr_b16 v[64:65], v9 offset:8192
    ds_read_b64_tr_b16 v[66:67], v9 offset:9216
    s_waitcnt lgkmcnt(8)
    v_mfma_f32_16x16x32_bf16 v[108:111], v[68:71], v[48:51], v[108:111]
    v_mfma_f32_16x16x32_bf16 v[136:139], v[68:71], v[52:55], v[136:139]
    s_waitcnt vmcnt(7)
    s_barrier
    ds_read_b64_tr_b16 v[68:69], v10 offset:8192
    ds_read_b64_tr_b16 v[70:71], v10 offset:9216
    s_waitcnt lgkmcnt(8)
    v_mfma_f32_16x16x32_bf16 v[84:87], v[72:75], v[56:59], v[84:87]
    v_mfma_f32_16x16x32_bf16 v[112:115], v[72:75], v[60:63], v[112:115]
    ds_read_b64_tr_b16 v[72:73], v11 offset:8192
    ds_read_b64_tr_b16 v[74:75], v11 offset:9216
    s_waitcnt lgkmcnt(8)
    v_mfma_f32_16x16x32_bf16 v[88:91], v[76:79], v[56:59], v[88:91]
    v_mfma_f32_16x16x32_bf16 v[116:119], v[76:79], v[60:63], v[116:119]
    ds_read_b128 v[48:51], v40 offset:51200
    ds_read_b128 v[52:55], v44 offset:51200
    ds_read_b64_tr_b16 v[76:77], v12 offset:8192
    ds_read_b64_tr_b16 v[78:79], v12 offset:9216
    s_waitcnt lgkmcnt(10)
    v_mfma_f32_16x16x32_bf16 v[92:95], v[80:83], v[56:59], v[92:95]
    v_mfma_f32_16x16x32_bf16 v[120:123], v[80:83], v[60:63], v[120:123]
    ds_read_b64_tr_b16 v[80:81], v6 offset:51200
    ds_read_b64_tr_b16 v[82:83], v6 offset:52224
    s_waitcnt lgkmcnt(10)
    v_mfma_f32_16x16x32_bf16 v[96:99], v[64:67], v[56:59], v[96:99]
    v_mfma_f32_16x16x32_bf16 v[124:127], v[64:67], v[60:63], v[124:127]
    v_mfma_f32_16x16x32_bf16 v[144:147], v[56:59], v[56:59], v[144:147]
    ds_read_b64_tr_b16 v[64:65], v7 offset:51200
    ds_read_b64_tr_b16 v[66:67], v7 offset:52224
    s_waitcnt lgkmcnt(10)
    v_mfma_f32_16x16x32_bf16 v[100:103], v[68:71], v[56:59], v[100:103]
    v_mfma_f32_16x16x32_bf16 v[128:131], v[68:71], v[60:63], v[128:131]
    ds_read_b64_tr_b16 v[68:69], v8 offset:51200
    ds_read_b64_tr_b16 v[70:71], v8 offset:52224
    s_waitcnt lgkmcnt(10)
    v_mfma_f32_16x16x32_bf16 v[104:107], v[72:75], v[56:59], v[104:107]
    v_mfma_f32_16x16x32_bf16 v[132:135], v[72:75], v[60:63], v[132:135]
    v_mfma_f32_16x16x32_bf16 v[140:143], v[36:39], v[56:59], v[140:143]
    ds_read_b64_tr_b16 v[72:73], v9 offset:51200
    ds_read_b64_tr_b16 v[74:75], v9 offset:52224
    s_waitcnt lgkmcnt(8)
    v_mfma_f32_16x16x32_bf16 v[108:111], v[76:79], v[56:59], v[108:111]
    v_mfma_f32_16x16x32_bf16 v[136:139], v[76:79], v[60:63], v[136:139]
    s_barrier
    ds_read_b64_tr_b16 v[76:77], v10 offset:51200
    ds_read_b64_tr_b16 v[78:79], v10 offset:52224
    s_waitcnt lgkmcnt(8)
    v_mfma_f32_16x16x32_bf16 v[84:87], v[80:83], v[48:51], v[84:87]
    v_mfma_f32_16x16x32_bf16 v[112:115], v[80:83], v[52:55], v[112:115]
    s_cmp_ge_u32 s42, 2
    s_cbranch_scc1 k1_dskip3
    s_add_u32 m0, s34, 0x0
    s_nop 0
    buffer_load_dwordx4 v164, s[28:31], s32 offen lds
    s_add_u32 s32, s32, s33
    s_cmp_eq_u32 s32, s35
    s_cselect_b32 s32, 0, s32
k1_dskip3:
    ds_read_b64_tr_b16 v[80:81], v11 offset:51200
    ds_read_b64_tr_b16 v[82:83], v11 offset:52224
    s_waitcnt lgkmcnt(8)
    v_mfma_f32_16x16x32_bf16 v[88:91], v[64:67], v[48:51], v[88:91]
    v_mfma_f32_16x16x32_bf16 v[116:119], v[64:67], v[52:55], v[116:119]
    s_add_u32 m0, s70, 0x0
    s_nop 0
    buffer_load_dwordx4 v160, s[64:67], s68 offen lds
    s_add_u32 s68, s68, s69
    s_cmp_eq_u32 s68, s71
    s_cselect_b32 s68, 0, s68
    ds_read_b128 v[56:59], v41 offset:51200
    ds_read_b128 v[60:63], v45 offset:51200
    ds_read_b64_tr_b16 v[64:65], v12 offset:51200
    ds_read_b64_tr_b16 v[66:67], v12 offset:52224
    s_waitcnt lgkmcnt(10)
    v_mfma_f32_16x16x32_bf16 v[92:95], v[68:71], v[48:51], v[92:95]
    v_mfma_f32_16x16x32_bf16 v[120:123], v[68:71], v[52:55], v[120:123]
    s_add_u32 m0, s78, 0x0
    s_nop 0
    buffer_load_dwordx4 v161, s[72:75], s76 offen lds
    s_add_u32 s76, s76, s77
    s_cmp_eq_u32 s76, s79
    s_cselect_b32 s76, 0, s76
    ds_read_b64_tr_b16 v[68:69], v6 offset:59392
    ds_read_b64_tr_b16 v[70:71], v6 offset:60416
    s_waitcnt lgkmcnt(10)
    v_mfma_f32_16x16x32_bf16 v[96:99], v[72:75], v[48:51], v[96:99]
    v_mfma_f32_16x16x32_bf16 v[124:127], v[72:75], v[52:55], v[124:127]
    v_mfma_f32_16x16x32_bf16 v[144:147], v[48:51], v[48:51], v[144:147]
    s_add_u32 m0, s86, 0x0
    s_nop 0
    buffer_load_dwordx4 v162, s[80:83], s84 offen lds
    s_add_u32 s84, s84, s85
    s_cmp_eq_u32 s84, s87
    s_cselect_b32 s84, 0, s84
    ds_read_b64_tr_b16 v[72:73], v7 offset:59392
    ds_read_b64_tr_b16 v[74:75], v7 offset:60416
    s_waitcnt lgkmcnt(10)
    v_mfma_f32_16x16x32_bf16 v[100:103], v[76:79], v[48:51], v[100:103]
    v_mfma_f32_16x16x32_bf16 v[128:131], v[76:79], v[52:55], v[128:131]
    s_add_u32 m0, s94, 0x0
    s_nop 0
    buffer_load_dwordx4 v163, s[88:91], s92 offen lds
    s_add_u32 s92, s92, s93
    s_cmp_eq_u32 s92, s95
    s_cselect_b32 s92, 0, s92
    ds_read_b64_tr_b16 v[76:77], v8 offset:59392
    ds_read_b64_tr_b16 v[78:79], v8 offset:60416
    s_waitcnt lgkmcnt(10)
    v_mfma_f32_16x16x32_bf16 v[104:107], v[80:83], v[48:51], v[104:107]
    v_mfma_f32_16x16x32_bf16 v[132:135], v[80:83], v[52:55], v[132:135]
    v_mfma_f32_16x16x32_bf16 v[140:143], v[36:39], v[48:51], v[140:143]
    ds_read_b64_tr_b16 v[80:81], v9 offset:59392
    ds_read_b64_tr_b16 v[82:83], v9 offset:60416
    s_waitcnt lgkmcnt(8)
    v_mfma_f32_16x16x32_bf16 v[108:111], v[64:67], v[48:51], v[108:111]
    v_mfma_f32_16x16x32_bf16 v[136:139], v[64:67], v[52:55], v[136:139]
    s_waitcnt vmcnt(4)
    s_barrier
    ds_read_b64_tr_b16 v[64:65], v10 offset:59392
    ds_read_b64_tr_b16 v[66:67], v10 offset:60416
    s_waitcnt lgkmcnt(8)
    v_mfma_f32_16x16x32_bf16 v[84:87], v[68:71], v[56:59], v[84:87]
    v_mfma_f32_16x16x32_bf16 v[112:115], v[68:71], v[60:63], v[112:115]
    ds_read_b64_tr_b16 v[68:69], v11 offset:59392
    ds_read_b64_tr_b16 v[70:71], v11 offset:60416
    s_waitcnt lgkmcnt(8)
    v_mfma_f32_16x16x32_bf16 v[88:91], v[72:75], v[56:59], v[88:91]
    v_mfma_f32_16x16x32_bf16 v[116:119], v[72:75], v[60:63], v[116:119]
    ds_read_b128 v[48:51], v42 offset:0
    ds_read_b128 v[52:55], v46 offset:0
    ds_read_b64_tr_b16 v[72:73], v12 offset:59392
    ds_read_b64_tr_b16 v[74:75], v12 offset:60416
    s_waitcnt lgkmcnt(10)
    v_mfma_f32_16x16x32_bf16 v[92:95], v[76:79], v[56:59], v[92:95]
    v_mfma_f32_16x16x32_bf16 v[120:123], v[76:79], v[60:63], v[120:123]
    ds_read_b64_tr_b16 v[76:77], v13 offset:0
    ds_read_b64_tr_b16 v[78:79], v13 offset:1024
    s_waitcnt lgkmcnt(10)
    v_mfma_f32_16x16x32_bf16 v[96:99], v[80:83], v[56:59], v[96:99]
    v_mfma_f32_16x16x32_bf16 v[124:127], v[80:83], v[60:63], v[124:127]
    v_mfma_f32_16x16x32_bf16 v[144:147], v[56:59], v[56:59], v[144:147]
    ds_read_b64_tr_b16 v[80:81], v14 offset:0
    ds_read_b64_tr_b16 v[82:83], v14 offset:1024
    s_waitcnt lgkmcnt(10)
    v_mfma_f32_16x16x32_bf16 v[100:103], v[64:67], v[56:59], v[100:103]
    v_mfma_f32_16x16x32_bf16 v[128:131], v[64:67], v[60:63], v[128:131]
    ds_read_b64_tr_b16 v[64:65], v15 offset:0
    ds_read_b64_tr_b16 v[66:67], v15 offset:1024
    s_waitcnt lgkmcnt(10)
    v_mfma_f32_16x16x32_bf16 v[104:107], v[68:71], v[56:59], v[104:107]
    v_mfma_f32_16x16x32_bf16 v[132:135], v[68:71], v[60:63], v[132:135]
    v_mfma_f32_16x16x32_bf16 v[140:143], v[36:39], v[56:59], v[140:143]
    ds_read_b64_tr_b16 v[68:69], v16 offset:0
    ds_read_b64_tr_b16 v[70:71], v16 offset:1024
    s_waitcnt lgkmcnt(8)
    v_mfma_f32_16x16x32_bf16 v[108:111], v[72:75], v[56:59], v[108:111]
    v_mfma_f32_16x16x32_bf16 v[136:139], v[72:75], v[60:63], v[136:139]
    s_barrier
    ds_read_b64_tr_b16 v[72:73], v17 offset:0
    ds_read_b64_tr_b16 v[74:75], v17 offset:1024
    s_waitcnt lgkmcnt(8)
    v_mfma_f32_16x16x32_bf16 v[84:87], v[76:79], v[48:51], v[84:87]
    v_mfma_f32_16x16x32_bf16 v[112:115], v[76:79], v[52:55], v[112:115]
    s_cmp_ge_u32 s42, 2
    s_cbranch_scc1 k1_dskip4
    s_add_u32 m0, s34, 0xc800
    s_nop 0
    buffer_load_dwordx4 v164, s[28:31], s32 offen lds
    s_add_u32 s32, s32, s33
    s_cmp_eq_u32 s32, s35
    s_cselect_b32 s32, 0, s32
k1_dskip4:
    ds_read_b64_tr_b16 v[76:77], v18 offset:0
    ds_read_b64_tr_b16 v[78:79], v18 offset:1024
    s_waitcnt lgkmcnt(8)
    v_mfma_f32_16x16x32_bf16 v[88:91], v[80:83], v[48:51], v[88:91]
    v_mfma_f32_16x16x32_bf16 v[116:119], v[80:83], v[52:55], v[116:119]
    s_add_u32 m0, s70, 0xc800
    s_nop 0
    buffer_load_dwordx4 v160, s[64:67], s68 offen lds
    s_add_u32 s68, s68, s69
    s_cmp_eq_u32 s68, s71
    s_cselect_b32 s68, 0, s68
    ds_read_b128 v[56:59], v43 offset:0
    ds_read_b128 v[60:63], v47 offset:0
    ds_read_b64_tr_b16 v[80:81], v19 offset:0
    ds_read_b64_tr_b16 v[82:83], v19 offset:1024
    s_waitcnt lgkmcnt(10)
    v_mfma_f32_16x16x32_bf16 v[92:95], v[64:67], v[48:51], v[92:95]
    v_mfma_f32_16x16x32_bf16 v[120:123], v[64:67], v[52:55], v[120:123]
    s_add_u32 m0, s78, 0xc800
    s_nop 0
    buffer_load_dwordx4 v161, s[72:75], s76 offen lds
    s_add_u32 s76, s76, s77
    s_cmp_eq_u32 s76, s79
    s_cselect_b32 s76, 0, s76
    ds_read_b64_tr_b16 v[64:65], v13 offset:8192
    ds_read_b64_tr_b16 v[66:67], v13 offset:9216
    s_waitcnt lgkmcnt(10)
    v_mfma_f32_16x16x32_bf16 v[96:99], v[68:71], v[48:51], v[96:99]
    v_mfma_f32_16x16x32_bf16 v[124:127], v[68:71], v[52:55], v[124:127]
    v_mfma_f32_16x16x32_bf16 v[144:147], v[48:51], v[48:51], v[144:147]
    s_add_u32 m0, s86, 0xc800
    s_nop 0
    buffer_load_dwordx4 v162, s[80:83], s84 offen lds
    s_add_u32 s84, s84, s85
    s_cmp_eq_u32 s84, s87
    s_cselect_b32 s84, 0, s84
    ds_read_b64_tr_b16 v[68:69], v14 offset:8192
    ds_read_b64_tr_b16 v[70:71], v14 offset:9216
    s_waitcnt lgkmcnt(10)
    v_mfma_f32_16x16x32_bf16 v[100:103], v[72:75], v[48:51], v[100:103]
    v_mfma_f32_16x16x32_bf16 v[128:131], v[72:75], v[52:55], v[128:131]
    s_add_u32 m0, s94, 0xc800
    s_nop 0
    buffer_load_dwordx4 v163, s[88:91], s92 offen lds
    s_add_u32 s92, s92, s93
    s_cmp_eq_u32 s92, s95
    s_cselect_b32 s92, 0, s92
    ds_read_b64_tr_b16 v[72:73], v15 offset:8192
    ds_read_b64_tr_b16 v[74:75], v15 offset:9216
    s_waitcnt lgkmcnt(10)
    v_mfma_f32_16x16x32_bf16 v[104:107], v[76:79], v[48:51], v[104:107]
    v_mfma_f32_16x16x32_bf16 v[132:135], v[76:79], v[52:55], v[132:135]
    v_mfma_f32_16x16x32_bf16 v[140:143], v[36:39], v[48:51], v[140:143]
    ds_read_b64_tr_b16 v[76:77], v16 offset:8192
    ds_read_b64_tr_b16 v[78:79], v16 offset:9216
    s_waitcnt lgkmcnt(8)
    v_mfma_f32_16x16x32_bf16 v[108:111], v[80:83], v[48:51], v[108:111]
    v_mfma_f32_16x16x32_bf16 v[136:139], v[80:83], v[52:55], v[136:139]
    s_waitcnt vmcnt(4)
    s_barrier
    ds_read_b64_tr_b16 v[80:81], v17 offset:8192
    ds_read_b64_tr_b16 v[82:83], v17 offset:9216
    s_waitcnt lgkmcnt(8)
    v_mfma_f32_16x16x32_bf16 v[84:87], v[64:67], v[56:59], v[84:87]
    v_mfma_f32_16x16x32_bf16 v[112:115], v[64:67], v[60:63], v[112:115]
    ds_read_b64_tr_b16 v[64:65], v18 offset:8192
    ds_read_b64_tr_b16 v[66:67], v18 offset:9216
    s_waitcnt lgkmcnt(8)
    v_mfma_f32_16x16x32_bf16 v[88:91], v[68:71], v[56:59], v[88:91]
    v_mfma_f32_16x16x32_bf16 v[116:119], v[68:71], v[60:63], v[116:119]
    ds_read_b128 v[48:51], v40 offset:0
    ds_read_b128 v[52:55], v44 offset:0
    ds_read_b64_tr_b16 v[68:69], v19 offset:8192
    ds_read_b64_tr_b16 v[70:71], v19 offset:9216
    s_waitcnt lgkmcnt(10)
    v_mfma_f32_16x16x32_bf16 v[92:95], v[72:75], v[56:59], v[92:95]
    v_mfma_f32_16x16x32_bf16 v[120:123], v[72:75], v[60:63], v[120:123]
    ds_read_b64_tr_b16 v[72:73], v6 offset:0
    ds_read_b64_tr_b16 v[74:75], v6 offset:1024
    s_waitcnt lgkmcnt(10)
    v_mfma_f32_16x16x32_bf16 v[96:99], v[76:79], v[56:59], v[96:99]
    v_mfma_f32_16x16x32_bf16 v[124:127], v[76:79], v[60:63], v[124:127]
    v_mfma_f32_16x16x32_bf16 v[144:147], v[56:59], v[56:59], v[144:147]
    ds_read_b64_tr_b16 v[76:77], v7 offset:0
    ds_read_b64_tr_b16 v[78:79], v7 offset:1024
    s_waitcnt lgkmcnt(10)
    v_mfma_f32_16x16x32_bf16 v[100:103], v[80:83], v[56:59], v[100:103]
    v_mfma_f32_16x16x32_bf16 v[128:131], v[80:83], v[60:63], v[128:131]
    ds_read_b64_tr_b16 v[80:81], v8 offset:0
    ds_read_b64_tr_b16 v[82:83], v8 offset:1024
    s_waitcnt lgkmcnt(10)
    v_mfma_f32_16x16x32_bf16 v[104:107], v[64:67], v[56:59], v[104:107]
    v_mfma_f32_16x16x32_bf16 v[132:135], v[64:67], v[60:63], v[132:135]
    v_mfma_f32_16x16x32_bf16 v[140:143], v[36:39], v[56:59], v[140:143]
    ds_read_b64_tr_b16 v[64:65], v9 offset:0
    ds_read_b64_tr_b16 v[66:67], v9 offset:1024
    s_waitcnt lgkmcnt(8)
    v_mfma_f32_16x16x32_bf16 v[108:111], v[68:71], v[56:59], v[108:111]
    v_mfma_f32_16x16x32_bf16 v[136:139], v[68:71], v[60:63], v[136:139]
    s_barrier
    ds_read_b64_tr_b16 v[68:69], v10 offset:0
    ds_read_b64_tr_b16 v[70:71], v10 offset:1024
    s_waitcnt lgkmcnt(8)
    v_mfma_f32_16x16x32_bf16 v[84:87], v[72:75], v[48:51], v[84:87]
    v_mfma_f32_16x16x32_bf16 v[112:115], v[72:75], v[52:55], v[112:115]
    s_cmp_ge_u32 s42, 2
    s_cbranch_scc1 k1_dskip5
    s_add_u32 m0, s34, 0x19000
    s_nop 0
    buffer_load_dwordx4 v164, s[28:31], s32 offen lds
    s_add_u32 s32, s32, s33
    s_cmp_eq_u32 s32, s35
    s_cselect_b32 s32, 0, s32
k1_dskip5:
    ds_read_b64_tr_b16 v[72:73], v11 offset:0
    ds_read_b64_tr_b16 v[74:75], v11 offset:1024
    s_waitcnt lgkmcnt(8)
    v_mfma_f32_16x16x32_bf16 v[88:91], v[76:79], v[48:51], v[88:91]
    v_mfma_f32_16x16x32_bf16 v[116:119], v[76:79], v[52:55], v[116:119]
    s_add_u32 m0, s70, 0x19000
    s_nop 0
    buffer_load_dwordx4 v160, s[64:67], s68 offen lds
    s_add_u32 s68, s68, s69
    s_cmp_eq_u32 s68, s71
    s_cselect_b32 s68, 0, s68
    ds_read_b128 v[56:59], v41 offset:0
    ds_read_b128 v[60:63], v45 offset:0
    ds_read_b64_tr_b16 v[76:77], v12 offset:0
    ds_read_b64_tr_b16 v[78:79], v12 offset:1024
    s_waitcnt lgkmcnt(10)
    v_mfma_f32_16x16x32_bf16 v[92:95], v[80:83], v[48:51], v[92:95]
    v_mfma_f32_16x16x32_bf16 v[120:123], v[80:83], v[52:55], v[120:123]
    s_add_u32 m0, s78, 0x19000
    s_nop 0
    buffer_load_dwordx4 v161, s[72:75], s76 offen lds
    s_add_u32 s76, s76, s77
    s_cmp_eq_u32 s76, s79
    s_cselect_b32 s76, 0, s76
    ds_read_b64_tr_b16 v[80:81], v6 offset:8192
    ds_read_b64_tr_b16 v[82:83], v6 offset:9216
    s_waitcnt lgkmcnt(10)
    v_mfma_f32_16x16x32_bf16 v[96:99], v[64:67], v[48:51], v[96:99]
    v_mfma_f32_16x16x32_bf16 v[124:127], v[64:67], v[52:55], v[124:127]
    v_mfma_f32_16x16x32_bf16 v[144:147], v[48:51], v[48:51], v[144:147]
    s_add_u32 m0, s86, 0x19000
    s_nop 0
    buffer_load_dwordx4 v162, s[80:83], s84 offen lds
    s_add_u32 s84, s84, s85
    s_cmp_eq_u32 s84, s87
    s_cselect_b32 s84, 0, s84
    ds_read_b64_tr_b16 v[64:65], v7 offset:8192
    ds_read_b64_tr_b16 v[66:67], v7 offset:9216
    s_waitcnt lgkmcnt(10)
    v_mfma_f32_16x16x32_bf16 v[100:103], v[68:71], v[48:51], v[100:103]
    v_mfma_f32_16x16x32_bf16 v[128:131], v[68:71], v[52:55], v[128:131]
    s_add_u32 m0, s94, 0x19000
    s_nop 0
    buffer_load_dwordx4 v163, s[88:91], s92 offen lds
    s_add_u32 s92, s92, s93
    s_cmp_eq_u32 s92, s95
    s_cselect_b32 s92, 0, s92
    ds_read_b64_tr_b16 v[68:69], v8 offset:8192
    ds_read_b64_tr_b16 v[70:71], v8 offset:9216
    s_waitcnt lgkmcnt(10)
    v_mfma_f32_16x16x32_bf16 v[104:107], v[72:75], v[48:51], v[104:107]
    v_mfma_f32_16x16x32_bf16 v[132:135], v[72:75], v[52:55], v[132:135]
    v_mfma_f32_16x16x32_bf16 v[140:143], v[36:39], v[48:51], v[140:143]
    ds_read_b64_tr_b16 v[72:73], v9 offset:8192
    ds_read_b64_tr_b16 v[74:75], v9 offset:9216
    s_waitcnt lgkmcnt(8)
    v_mfma_f32_16x16x32_bf16 v[108:111], v[76:79], v[48:51], v[108:111]
    v_mfma_f32_16x16x32_bf16 v[136:139], v[76:79], v[52:55], v[136:139]
    s_waitcnt vmcnt(4)
    s_barrier
    ds_read_b64_tr_b16 v[76:77], v10 offset:8192
    ds_read_b64_tr_b16 v[78:79], v10 offset:9216
    s_waitcnt lgkmcnt(8)
    v_mfma_f32_16x16x32_bf16 v[84:87], v[80:83], v[56:59], v[84:87]
    v_mfma_f32_16x16x32_bf16 v[112:115], v[80:83], v[60:63], v[112:115]
    ds_read_b64_tr_b16 v[80:81], v11 offset:8192
    ds_read_b64_tr_b16 v[82:83], v11 offset:9216
    s_waitcnt lgkmcnt(8)
    v_mfma_f32_16x16x32_bf16 v[88:91], v[64:67], v[56:59], v[88:91]
    v_mfma_f32_16x16x32_bf16 v[116:119], v[64:67], v[60:63], v[116:119]
    ds_read_b128 v[48:51], v40 offset:51200
    ds_read_b128 v[52:55], v44 offset:51200
    ds_read_b64_tr_b16 v[64:65], v12 offset:8192
    ds_read_b64_tr_b16 v[66:67], v12 offset:9216
    s_waitcnt lgkmcnt(10)
    v_mfma_f32_16x16x32_bf16 v[92:95], v[68:71], v[56:59], v[92:95]
    v_mfma_f32_16x16x32_bf16 v[120:123], v[68:71], v[60:63], v[120:123]
    ds_read_b64_tr_b16 v[68:69], v6 offset:51200
    ds_read_b64_tr_b16 v[70:71], v6 offset:52224
    s_waitcnt lgkmcnt(10)
    v_mfma_f32_16x16x32_bf16 v[96:99], v[72:75], v[56:59], v[96:99]
    v_mfma_f32_16x16x32_bf16 v[124:127], v[72:75], v[60:63], v[124:127]
    v_mfma_f32_16x16x32_bf16 v[144:147], v[56:59], v[56:59], v[144:147]
    ds_read_b64_tr_b16 v[72:73], v7 offset:51200
    ds_read_b64_tr_b16 v[74:75], v7 offset:52224
    s_waitcnt lgkmcnt(10)
    v_mfma_f32_16x16x32_bf16 v[100:103], v[76:79], v[56:59], v[100:103]
    v_mfma_f32_16x16x32_bf16 v[128:131], v[76:79], v[60:63], v[128:131]
    ds_read_b64_tr_b16 v[76:77], v8 offset:51200
    ds_read_b64_tr_b16 v[78:79], v8 offset:52224
    s_waitcnt lgkmcnt(10)
    v_mfma_f32_16x16x32_bf16 v[104:107], v[80:83], v[56:59], v[104:107]
    v_mfma_f32_16x16x32_bf16 v[132:135], v[80:83], v[60:63], v[132:135]
    v_mfma_f32_16x16x32_bf16 v[140:143], v[36:39], v[56:59], v[140:143]
    ds_read_b64_tr_b16 v[80:81], v9 offset:51200
    ds_read_b64_tr_b16 v[82:83], v9 offset:52224
    s_waitcnt lgkmcnt(8)
    v_mfma_f32_16x16x32_bf16 v[108:111], v[64:67], v[56:59], v[108:111]
    v_mfma_f32_16x16x32_bf16 v[136:139], v[64:67], v[60:63], v[136:139]
    s_barrier
    ds_read_b64_tr_b16 v[64:65], v10 offset:51200
    ds_read_b64_tr_b16 v[66:67], v10 offset:52224
    s_waitcnt lgkmcnt(8)
    v_mfma_f32_16x16x32_bf16 v[84:87], v[68:71], v[48:51], v[84:87]
    v_mfma_f32_16x16x32_bf16 v[112:115], v[68:71], v[52:55], v[112:115]
    s_cmp_ge_u32 s42, 2
    s_cbranch_scc1 k1_dskip6
    s_add_u32 m0, s34, 0x0
    s_nop 0
    buffer_load_dwordx4 v164, s[28:31], s32 offen lds
    s_add_u32 s32, s32, s33
    s_cmp_eq_u32 s32, s35
    s_cselect_b32 s32, 0, s32
k1_dskip6:
    ds_read_b64_tr_b16 v[68:69], v11 offset:51200
    ds_read_b64_tr_b16 v[70:71], v11 offset:52224
    s_waitcnt lgkmcnt(8)
    v_mfma_f32_16x16x32_bf16 v[88:91], v[72:75], v[48:51], v[88:91]
    v_mfma_f32_16x16x32_bf16 v[116:119], v[72:75], v[52:55], v[116:119]
    s_add_u32 m0, s70, 0x0
    s_nop 0
    buffer_load_dwordx4 v160, s[64:67], s68 offen lds
    s_add_u32 s68, s68, s69
    s_cmp_eq_u32 s68, s71
    s_cselect_b32 s68, 0, s68
    ds_read_b128 v[56:59], v41 offset:51200
    ds_read_b128 v[60:63], v45 offset:51200
    ds_read_b64_tr_b16 v[72:73], v12 offset:51200
    ds_read_b64_tr_b16 v[74:75], v12 offset:52224
    s_waitcnt lgkmcnt(10)
    v_mfma_f32_16x16x32_bf16 v[92:95], v[76:79], v[48:51], v[92:95]
    v_mfma_f32_16x16x32_bf16 v[120:123], v[76:79], v[52:55], v[120:123]
    s_add_u32 m0, s78, 0x0
    s_nop 0
    buffer_load_dwordx4 v161, s[72:75], s76 offen lds
    s_add_u32 s76, s76, s77
    s_cmp_eq_u32 s76, s79
    s_cselect_b32 s76, 0, s76
    ds_read_b64_tr_b16 v[76:77], v6 offset:59392
    ds_read_b64_tr_b16 v[78:79], v6 offset:60416
    s_waitcnt lgkmcnt(10)
    v_mfma_f32_16x16x32_bf16 v[96:99], v[80:83], v[48:51], v[96:99]
    v_mfma_f32_16x16x32_bf16 v[124:127], v[80:83], v[52:55], v[124:127]
    v_mfma_f32_16x16x32_bf16 v[144:147], v[48:51], v[48:51], v[144:147]
    s_add_u32 m0, s86, 0x0
    s_nop 0
    buffer_load_dwordx4 v162, s[80:83], s84 offen lds
    s_add_u32 s84, s84, s85
    s_cmp_eq_u32 s84, s87
    s_cselect_b32 s84, 0, s84
    ds_read_b64_tr_b16 v[80:81], v7 offset:59392
    ds_read_b64_tr_b16 v[82:83], v7 offset:60416
    s_waitcnt lgkmcnt(10)
    v_mfma_f32_16x16x32_bf16 v[100:103], v[64:67], v[48:51], v[100:103]
    v_mfma_f32_16x16x32_bf16 v[128:131], v[64:67], v[52:55], v[128:131]
    s_add_u32 m0, s94, 0x0
    s_nop 0
    buffer_load_dwordx4 v163, s[88:91], s92 offen lds
    s_add_u32 s92, s92, s93
    s_cmp_eq_u32 s92, s95
    s_cselect_b32 s92, 0, s92
    ds_read_b64_tr_b16 v[64:65], v8 offset:59392
    ds_read_b64_tr_b16 v[66:67], v8 offset:60416
    s_waitcnt lgkmcnt(10)
    v_mfma_f32_16x16x32_bf16 v[104:107], v[68:71], v[48:51], v[104:107]
    v_mfma_f32_16x16x32_bf16 v[132:135], v[68:71], v[52:55], v[132:135]
    v_mfma_f32_16x16x32_bf16 v[140:143], v[36:39], v[48:51], v[140:143]
    ds_read_b64_tr_b16 v[68:69], v9 offset:59392
    ds_read_b64_tr_b16 v[70:71], v9 offset:60416
    s_waitcnt lgkmcnt(8)
    v_mfma_f32_16x16x32_bf16 v[108:111], v[72:75], v[48:51], v[108:111]
    v_mfma_f32_16x16x32_bf16 v[136:139], v[72:75], v[52:55], v[136:139]
    s_waitcnt vmcnt(4)
    s_barrier
    ds_read_b64_tr_b16 v[72:73], v10 offset:59392
    ds_read_b64_tr_b16 v[74:75], v10 offset:60416
    s_waitcnt lgkmcnt(8)
    v_mfma_f32_16x16x32_bf16 v[84:87], v[76:79], v[56:59], v[84:87]
    v_mfma_f32_16x16x32_bf16 v[112:115], v[76:79], v[60:63], v[112:115]
    ds_read_b64_tr_b16 v[76:77], v11 offset:59392
    ds_read_b64_tr_b16 v[78:79], v11 offset:60416
    s_waitcnt lgkmcnt(8)
    v_mfma_f32_16x16x32_bf16 v[88:91], v[80:83], v[56:59], v[88:91]
    v_mfma_f32_16x16x32_bf16 v[116:119], v[80:83], v[60:63], v[116:119]
    ds_read_b128 v[48:51], v42 offset:0
    ds_read_b128 v[52:55], v46 offset:0
    ds_read_b64_tr_b16 v[80:81], v12 offset:59392
    ds_read_b64_tr_b16 v[82:83], v12 offset:60416
    s_waitcnt lgkmcnt(10)
    v_mfma_f32_16x16x32_bf16 v[92:95], v[64:67], v[56:59], v[92:95]
    v_mfma_f32_16x16x32_bf16 v[120:123], v[64:67], v[60:63], v[120:123]
    ds_read_b64_tr_b16 v[64:65], v13 offset:0
    ds_read_b64_tr_b16 v[66:67], v13 offset:1024
    s_waitcnt lgkmcnt(10)
    v_mfma_f32_16x16x32_bf16 v[96:99], v[68:71], v[56:59], v[96:99]
    v_mfma_f32_16x16x32_bf16 v[124:127], v[68:71], v[60:63], v[124:127]
    v_mfma_f32_16x16x32_bf16 v[144:147], v[56:59], v[56:59], v[144:147]
    ds_read_b64_tr_b16 v[68:69], v14 offset:0
    ds_read_b64_tr_b16 v[70:71], v14 offset:1024
    s_waitcnt lgkmcnt(10)
    v_mfma_f32_16x16x32_bf16 v[100:103], v[72:75], v[56:59], v[100:103]
    v_mfma_f32_16x16x32_bf16 v[128:131], v[72:75], v[60:63], v[128:131]
    ds_read_b64_tr_b16 v[72:73], v15 offset:0
    ds_read_b64_tr_b16 v[74:75], v15 offset:1024
    s_waitcnt lgkmcnt(10)
    v_mfma_f32_16x16x32_bf16 v[104:107], v[76:79], v[56:59], v[104:107]
    v_mfma_f32_16x16x32_bf16 v[132:135], v[76:79], v[60:63], v[132:135]
    v_mfma_f32_16x16x32_bf16 v[140:143], v[36:39], v[56:59], v[140:143]
    ds_read_b64_tr_b16 v[76:77], v16 offset:0
    ds_read_b64_tr_b16 v[78:79], v16 offset:1024
    s_waitcnt lgkmcnt(8)
    v_mfma_f32_16x16x32_bf16 v[108:111], v[80:83], v[56:59], v[108:111]
    v_mfma_f32_16x16x32_bf16 v[136:139], v[80:83], v[60:63], v[136:139]
    s_barrier
    ds_read_b64_tr_b16 v[80:81], v17 offset:0
    ds_read_b64_tr_b16 v[82:83], v17 offset:1024
    s_waitcnt lgkmcnt(8)
    v_mfma_f32_16x16x32_bf16 v[84:87], v[64:67], v[48:51], v[84:87]
    v_mfma_f32_16x16x32_bf16 v[112:115], v[64:67], v[52:55], v[112:115]
    s_cmp_ge_u32 s42, 2
    s_cbranch_scc1 k1_dskip7
    s_add_u32 m0, s34, 0xc800
    s_nop 0
    buffer_load_dwordx4 v164, s[28:31], s32 offen lds
    s_add_u32 s32, s32, s33
    s_cmp_eq_u32 s32, s35
    s_cselect_b32 s32, 0, s32
k1_dskip7:
    ds_read_b64_tr_b16 v[64:65], v18 offset:0
    ds_read_b64_tr_b16 v[66:67], v18 offset:1024
    s_waitcnt lgkmcnt(8)
    v_mfma_f32_16x16x32_bf16 v[88:91], v[68:71], v[48:51], v[88:91]
    v_mfma_f32_16x16x32_bf16 v[116:119], v[68:71], v[52:55], v[116:119]
    s_add_u32 m0, s70, 0xc800
    s_nop 0
    buffer_load_dwordx4 v160, s[64:67], s68 offen lds
    s_add_u32 s68, s68, s69
    s_cmp_eq_u32 s68, s71
    s_cselect_b32 s68, 0, s68
    ds_read_b128 v[56:59], v43 offset:0
    ds_read_b128 v[60:63], v47 offset:0
    ds_read_b64_tr_b16 v[68:69], v19 offset:0
    ds_read_b64_tr_b16 v[70:71], v19 offset:1024
    s_waitcnt lgkmcnt(10)
    v_mfma_f32_16x16x32_bf16 v[92:95], v[72:75], v[48:51], v[92:95]
    v_mfma_f32_16x16x32_bf16 v[120:123], v[72:75], v[52:55], v[120:123]
    s_add_u32 m0, s78, 0xc800
    s_nop 0
    buffer_load_dwordx4 v161, s[72:75], s76 offen lds
    s_add_u32 s76, s76, s77
    s_cmp_eq_u32 s76, s79
    s_cselect_b32 s76, 0, s76
    ds_read_b64_tr_b16 v[72:73], v13 offset:8192
    ds_read_b64_tr_b16 v[74:75], v13 offset:9216
    s_waitcnt lgkmcnt(10)
    v_mfma_f32_16x16x32_bf16 v[96:99], v[76:79], v[48:51], v[96:99]
    v_mfma_f32_16x16x32_bf16 v[124:127], v[76:79], v[52:55], v[124:127]
    v_mfma_f32_16x16x32_bf16 v[144:147], v[48:51], v[48:51], v[144:147]
    s_add_u32 m0, s86, 0xc800
    s_nop 0
    buffer_load_dwordx4 v162, s[80:83], s84 offen lds
    s_add_u32 s84, s84, s85
    s_cmp_eq_u32 s84, s87
    s_cselect_b32 s84, 0, s84
    ds_read_b64_tr_b16 v[76:77], v14 offset:8192
    ds_read_b64_tr_b16 v[78:79], v14 offset:9216
    s_waitcnt lgkmcnt(10)
    v_mfma_f32_16x16x32_bf16 v[100:103], v[80:83], v[48:51], v[100:103]
    v_mfma_f32_16x16x32_bf16 v[128:131], v[80:83], v[52:55], v[128:131]
    s_add_u32 m0, s94, 0xc800
    s_nop 0
    buffer_load_dwordx4 v163, s[88:91], s92 offen lds
    s_add_u32 s92, s92, s93
    s_cmp_eq_u32 s92, s95
    s_cselect_b32 s92, 0, s92
    ds_read_b64_tr_b16 v[80:81], v15 offset:8192
    ds_read_b64_tr_b16 v[82:83], v15 offset:9216
    s_waitcnt lgkmcnt(10)
    v_mfma_f32_16x16x32_bf16 v[104:107], v[64:67], v[48:51], v[104:107]
    v_mfma_f32_16x16x32_bf16 v[132:135], v[64:67], v[52:55], v[132:135]
    v_mfma_f32_16x16x32_bf16 v[140:143], v[36:39], v[48:51], v[140:143]
    ds_read_b64_tr_b16 v[64:65], v16 offset:8192
    ds_read_b64_tr_b16 v[66:67], v16 offset:9216
    s_waitcnt lgkmcnt(8)
    v_mfma_f32_16x16x32_bf16 v[108:111], v[68:71], v[48:51], v[108:111]
    v_mfma_f32_16x16x32_bf16 v[136:139], v[68:71], v[52:55], v[136:139]
    s_waitcnt vmcnt(4)
    s_barrier
    ds_read_b64_tr_b16 v[68:69], v17 offset:8192
    ds_read_b64_tr_b16 v[70:71], v17 offset:9216
    s_waitcnt lgkmcnt(8)
    v_mfma_f32_16x16x32_bf16 v[84:87], v[72:75], v[56:59], v[84:87]
    v_mfma_f32_16x16x32_bf16 v[112:115], v[72:75], v[60:63], v[112:115]
    ds_read_b64_tr_b16 v[72:73], v18 offset:8192
    ds_read_b64_tr_b16 v[74:75], v18 offset:9216
    s_waitcnt lgkmcnt(8)
    v_mfma_f32_16x16x32_bf16 v[88:91], v[76:79], v[56:59], v[88:91]
    v_mfma_f32_16x16x32_bf16 v[116:119], v[76:79], v[60:63], v[116:119]
    ds_read_b128 v[48:51], v40 offset:0
    ds_read_b128 v[52:55], v44 offset:0
    ds_read_b64_tr_b16 v[76:77], v19 offset:8192
    ds_read_b64_tr_b16 v[78:79], v19 offset:9216
    s_waitcnt lgkmcnt(10)
    v_mfma_f32_16x16x32_bf16 v[92:95], v[80:83], v[56:59], v[92:95]
    v_mfma_f32_16x16x32_bf16 v[120:123], v[80:83], v[60:63], v[120:123]
    ds_read_b64_tr_b16 v[80:81], v6 offset:0
    ds_read_b64_tr_b16 v[82:83], v6 offset:1024
    s_waitcnt lgkmcnt(10)
    v_mfma_f32_16x16x32_bf16 v[96:99], v[64:67], v[56:59], v[96:99]
    v_mfma_f32_16x16x32_bf16 v[124:127], v[64:67], v[60:63], v[124:127]
    v_mfma_f32_16x16x32_bf16 v[144:147], v[56:59], v[56:59], v[144:147]
    ds_read_b64_tr_b16 v[64:65], v7 offset:0
    ds_read_b64_tr_b16 v[66:67], v7 offset:1024
    s_waitcnt lgkmcnt(10)
    v_mfma_f32_16x16x32_bf16 v[100:103], v[68:71], v[56:59], v[100:103]
    v_mfma_f32_16x16x32_bf16 v[128:131], v[68:71], v[60:63], v[128:131]
    ds_read_b64_tr_b16 v[68:69], v8 offset:0
    ds_read_b64_tr_b16 v[70:71], v8 offset:1024
    s_waitcnt lgkmcnt(10)
    v_mfma_f32_16x16x32_bf16 v[104:107], v[72:75], v[56:59], v[104:107]
    v_mfma_f32_16x16x32_bf16 v[132:135], v[72:75], v[60:63], v[132:135]
    v_mfma_f32_16x16x32_bf16 v[140:143], v[36:39], v[56:59], v[140:143]
    ds_read_b64_tr_b16 v[72:73], v9 offset:0
    ds_read_b64_tr_b16 v[74:75], v9 offset:1024
    s_waitcnt lgkmcnt(8)
    v_mfma_f32_16x16x32_bf16 v[108:111], v[76:79], v[56:59], v[108:111]
    v_mfma_f32_16x16x32_bf16 v[136:139], v[76:79], v[60:63], v[136:139]
    s_barrier
    ds_read_b64_tr_b16 v[76:77], v10 offset:0
    ds_read_b64_tr_b16 v[78:79], v10 offset:1024
    s_waitcnt lgkmcnt(8)
    v_mfma_f32_16x16x32_bf16 v[84:87], v[80:83], v[48:51], v[84:87]
    v_mfma_f32_16x16x32_bf16 v[112:115], v[80:83], v[52:55], v[112:115]
    s_cmp_ge_u32 s42, 2
    s_cbranch_scc1 k1_dskip8
    s_add_u32 m0, s34, 0x19000
    s_nop 0
    buffer_load_dwordx4 v164, s[28:31], s32 offen lds
    s_add_u32 s32, s32, s33
    s_cmp_eq_u32 s32, s35
    s_cselect_b32 s32, 0, s32
k1_dskip8:
    ds_read_b64_tr_b16 v[80:81], v11 offset:0
    ds_read_b64_tr_b16 v[82:83], v11 offset:1024
    s_waitcnt lgkmcnt(8)
    v_mfma_f32_16x16x32_bf16 v[88:91], v[64:67], v[48:51], v[88:91]
    v_mfma_f32_16x16x32_bf16 v[116:119], v[64:67], v[52:55], v[116:119]
    s_add_u32 m0, s70, 0x19000
    s_nop 0
    buffer_load_dwordx4 v160, s[64:67], s68 offen lds
    s_add_u32 s68, s68, s69
    s_cmp_eq_u32 s68, s71
    s_cselect_b32 s68, 0, s68
    ds_read_b128 v[56:59], v41 offset:0
    ds_read_b128 v[60:63], v45 offset:0
    ds_read_b64_tr_b16 v[64:65], v12 offset:0
    ds_read_b64_tr_b16 v[66:67], v12 offset:1024
    s_waitcnt lgkmcnt(10)
    v_mfma_f32_16x16x32_bf16 v[92:95], v[68:71], v[48:51], v[92:95]
    v_mfma_f32_16x16x32_bf16 v[120:123], v[68:71], v[52:55], v[120:123]
    s_add_u32 m0, s78, 0x19000
    s_nop 0
    buffer_load_dwordx4 v161, s[72:75], s76 offen lds
    s_add_u32 s76, s76, s77
    s_cmp_eq_u32 s76, s79
    s_cselect_b32 s76, 0, s76
    ds_read_b64_tr_b16 v[68:69], v6 offset:8192
    ds_read_b64_tr_b16 v[70:71], v6 offset:9216
    s_waitcnt lgkmcnt(10)
    v_mfma_f32_16x16x32_bf16 v[96:99], v[72:75], v[48:51], v[96:99]
    v_mfma_f32_16x16x32_bf16 v[124:127], v[72:75], v[52:55], v[124:127]
    v_mfma_f32_16x16x32_bf16 v[144:147], v[48:51], v[48:51], v[144:147]
    s_add_u32 m0, s86, 0x19000
    s_nop 0
    buffer_load_dwordx4 v162, s[80:83], s84 offen lds
    s_add_u32 s84, s84, s85
    s_cmp_eq_u32 s84, s87
    s_cselect_b32 s84, 0, s84
    ds_read_b64_tr_b16 v[72:73], v7 offset:8192
    ds_read_b64_tr_b16 v[74:75], v7 offset:9216
    s_waitcnt lgkmcnt(10)
    v_mfma_f32_16x16x32_bf16 v[100:103], v[76:79], v[48:51], v[100:103]
    v_mfma_f32_16x16x32_bf16 v[128:131], v[76:79], v[52:55], v[128:131]
    s_add_u32 m0, s94, 0x19000
    s_nop 0
    buffer_load_dwordx4 v163, s[88:91], s92 offen lds
    s_add_u32 s92, s92, s93
    s_cmp_eq_u32 s92, s95
    s_cselect_b32 s92, 0, s92
    ds_read_b64_tr_b16 v[76:77], v8 offset:8192
    ds_read_b64_tr_b16 v[78:79], v8 offset:9216
    s_waitcnt lgkmcnt(10)
    v_mfma_f32_16x16x32_bf16 v[104:107], v[80:83], v[48:51], v[104:107]
    v_mfma_f32_16x16x32_bf16 v[132:135], v[80:83], v[52:55], v[132:135]
    v_mfma_f32_16x16x32_bf16 v[140:143], v[36:39], v[48:51], v[140:143]
    ds_read_b64_tr_b16 v[80:81], v9 offset:8192
    ds_read_b64_tr_b16 v[82:83], v9 offset:9216
    s_waitcnt lgkmcnt(8)
    v_mfma_f32_16x16x32_bf16 v[108:111], v[64:67], v[48:51], v[108:111]
    v_mfma_f32_16x16x32_bf16 v[136:139], v[64:67], v[52:55], v[136:139]
    s_waitcnt vmcnt(4)
    s_barrier
    ds_read_b64_tr_b16 v[64:65], v10 offset:8192
    ds_read_b64_tr_b16 v[66:67], v10 offset:9216
    s_waitcnt lgkmcnt(8)
    v_mfma_f32_16x16x32_bf16 v[84:87], v[68:71], v[56:59], v[84:87]
    v_mfma_f32_16x16x32_bf16 v[112:115], v[68:71], v[60:63], v[112:115]
    ds_read_b64_tr_b16 v[68:69], v11 offset:8192
    ds_read_b64_tr_b16 v[70:71], v11 offset:9216
    s_waitcnt lgkmcnt(8)
    v_mfma_f32_16x16x32_bf16 v[88:91], v[72:75], v[56:59], v[88:91]
    v_mfma_f32_16x16x32_bf16 v[116:119], v[72:75], v[60:63], v[116:119]
    ds_read_b128 v[48:51], v40 offset:51200
    ds_read_b128 v[52:55], v44 offset:51200
    ds_read_b64_tr_b16 v[72:73], v12 offset:8192
    ds_read_b64_tr_b16 v[74:75], v12 offset:9216
    s_waitcnt lgkmcnt(10)
    v_mfma_f32_16x16x32_bf16 v[92:95], v[76:79], v[56:59], v[92:95]
    v_mfma_f32_16x16x32_bf16 v[120:123], v[76:79], v[60:63], v[120:123]
    ds_read_b64_tr_b16 v[76:77], v6 offset:51200
    ds_read_b64_tr_b16 v[78:79], v6 offset:52224
    s_waitcnt lgkmcnt(10)
    v_mfma_f32_16x16x32_bf16 v[96:99], v[80:83], v[56:59], v[96:99]
    v_mfma_f32_16x16x32_bf16 v[124:127], v[80:83], v[60:63], v[124:127]
    v_mfma_f32_16x16x32_bf16 v[144:147], v[56:59], v[56:59], v[144:147]
    ds_read_b64_tr_b16 v[80:81], v7 offset:51200
    ds_read_b64_tr_b16 v[82:83], v7 offset:52224
    s_waitcnt lgkmcnt(10)
    v_mfma_f32_16x16x32_bf16 v[100:103], v[64:67], v[56:59], v[100:103]
    v_mfma_f32_16x16x32_bf16 v[128:131], v[64:67], v[60:63], v[128:131]
    ds_read_b64_tr_b16 v[64:65], v8 offset:51200
    ds_read_b64_tr_b16 v[66:67], v8 offset:52224
    s_waitcnt lgkmcnt(10)
    v_mfma_f32_16x16x32_bf16 v[104:107], v[68:71], v[56:59], v[104:107]
    v_mfma_f32_16x16x32_bf16 v[132:135], v[68:71], v[60:63], v[132:135]
    v_mfma_f32_16x16x32_bf16 v[140:143], v[36:39], v[56:59], v[140:143]
    ds_read_b64_tr_b16 v[68:69], v9 offset:51200
    ds_read_b64_tr_b16 v[70:71], v9 offset:52224
    s_waitcnt lgkmcnt(8)
    v_mfma_f32_16x16x32_bf16 v[108:111], v[72:75], v[56:59], v[108:111]
    v_mfma_f32_16x16x32_bf16 v[136:139], v[72:75], v[60:63], v[136:139]
    s_barrier
    ds_read_b64_tr_b16 v[72:73], v10 offset:51200
    ds_read_b64_tr_b16 v[74:75], v10 offset:52224
    s_waitcnt lgkmcnt(8)
    v_mfma_f32_16x16x32_bf16 v[84:87], v[76:79], v[48:51], v[84:87]
    v_mfma_f32_16x16x32_bf16 v[112:115], v[76:79], v[52:55], v[112:115]
    s_cmp_ge_u32 s42, 2
    s_cbranch_scc1 k1_dskip9
    s_add_u32 m0, s34, 0x0
    s_nop 0
    buffer_load_dwordx4 v164, s[28:31], s32 offen lds
    s_add_u32 s32, s32, s33
    s_cmp_eq_u32 s32, s35
    s_cselect_b32 s32, 0, s32
k1_dskip9:
    ds_read_b64_tr_b16 v[76:77], v11 offset:51200
    ds_read_b64_tr_b16 v[78:79], v11 offset:52224
    s_waitcnt lgkmcnt(8)
    v_mfma_f32_16x16x32_bf16 v[88:91], v[80:83], v[48:51], v[88:91]
    v_mfma_f32_16x16x32_bf16 v[116:119], v[80:83], v[52:55], v[116:119]
    s_add_u32 m0, s70, 0x0
    s_nop 0
    buffer_load_dwordx4 v160, s[64:67], s68 offen lds
    s_add_u32 s68, s68, s69
    s_cmp_eq_u32 s68, s71
    s_cselect_b32 s68, 0, s68
    ds_read_b128 v[56:59], v41 offset:51200
    ds_read_b128 v[60:63], v45 offset:51200
    ds_read_b64_tr_b16 v[80:81], v12 offset:51200
    ds_read_b64_tr_b16 v[82:83], v12 offset:52224
    s_waitcnt lgkmcnt(10)
    v_mfma_f32_16x16x32_bf16 v[92:95], v[64:67], v[48:51], v[92:95]
    v_mfma_f32_16x16x32_bf16 v[120:123], v[64:67], v[52:55], v[120:123]
    s_add_u32 m0, s78, 0x0
    s_nop 0
    buffer_load_dwordx4 v161, s[72:75], s76 offen lds
    s_add_u32 s76, s76, s77
    s_cmp_eq_u32 s76, s79
    s_cselect_b32 s76, 0, s76
    ds_read_b64_tr_b16 v[64:65], v6 offset:59392
    ds_read_b64_tr_b16 v[66:67], v6 offset:60416
    s_waitcnt lgkmcnt(10)
    v_mfma_f32_16x16x32_bf16 v[96:99], v[68:71], v[48:51], v[96:99]
    v_mfma_f32_16x16x32_bf16 v[124:127], v[68:71], v[52:55], v[124:127]
    v_mfma_f32_16x16x32_bf16 v[144:147], v[48:51], v[48:51], v[144:147]
    s_add_u32 m0, s86, 0x0
    s_nop 0
    buffer_load_dwordx4 v162, s[80:83], s84 offen lds
    s_add_u32 s84, s84, s85
    s_cmp_eq_u32 s84, s87
    s_cselect_b32 s84, 0, s84
    ds_read_b64_tr_b16 v[68:69], v7 offset:59392
    ds_read_b64_tr_b16 v[70:71], v7 offset:60416
    s_waitcnt lgkmcnt(10)
    v_mfma_f32_16x16x32_bf16 v[100:103], v[72:75], v[48:51], v[100:103]
    v_mfma_f32_16x16x32_bf16 v[128:131], v[72:75], v[52:55], v[128:131]
    s_add_u32 m0, s94, 0x0
    s_nop 0
    buffer_load_dwordx4 v163, s[88:91], s92 offen lds
    s_add_u32 s92, s92, s93
    s_cmp_eq_u32 s92, s95
    s_cselect_b32 s92, 0, s92
    ds_read_b64_tr_b16 v[72:73], v8 offset:59392
    ds_read_b64_tr_b16 v[74:75], v8 offset:60416
    s_waitcnt lgkmcnt(10)
    v_mfma_f32_16x16x32_bf16 v[104:107], v[76:79], v[48:51], v[104:107]
    v_mfma_f32_16x16x32_bf16 v[132:135], v[76:79], v[52:55], v[132:135]
    v_mfma_f32_16x16x32_bf16 v[140:143], v[36:39], v[48:51], v[140:143]
    ds_read_b64_tr_b16 v[76:77], v9 offset:59392
    ds_read_b64_tr_b16 v[78:79], v9 offset:60416
    s_waitcnt lgkmcnt(8)
    v_mfma_f32_16x16x32_bf16 v[108:111], v[80:83], v[48:51], v[108:111]
    v_mfma_f32_16x16x32_bf16 v[136:139], v[80:83], v[52:55], v[136:139]
    s_waitcnt vmcnt(4)
    s_barrier
    ds_read_b64_tr_b16 v[80:81], v10 offset:59392
    ds_read_b64_tr_b16 v[82:83], v10 offset:60416
    s_waitcnt lgkmcnt(8)
    v_mfma_f32_16x16x32_bf16 v[84:87], v[64:67], v[56:59], v[84:87]
    v_mfma_f32_16x16x32_bf16 v[112:115], v[64:67], v[60:63], v[112:115]
    ds_read_b64_tr_b16 v[64:65], v11 offset:59392
    ds_read_b64_tr_b16 v[66:67], v11 offset:60416
    s_waitcnt lgkmcnt(8)
    v_mfma_f32_16x16x32_bf16 v[88:91], v[68:71], v[56:59], v[88:91]
    v_mfma_f32_16x16x32_bf16 v[116:119], v[68:71], v[60:63], v[116:119]
    ds_read_b128 v[48:51], v42 offset:0
    ds_read_b128 v[52:55], v46 offset:0
    ds_read_b64_tr_b16 v[68:69], v12 offset:59392
    ds_read_b64_tr_b16 v[70:71], v12 offset:60416
    s_waitcnt lgkmcnt(10)
    v_mfma_f32_16x16x32_bf16 v[92:95], v[72:75], v[56:59], v[92:95]
    v_mfma_f32_16x16x32_bf16 v[120:123], v[72:75], v[60:63], v[120:123]
    ds_read_b64_tr_b16 v[72:73], v13 offset:0
    ds_read_b64_tr_b16 v[74:75], v13 offset:1024
    s_waitcnt lgkmcnt(10)
    v_mfma_f32_16x16x32_bf16 v[96:99], v[76:79], v[56:59], v[96:99]
    v_mfma_f32_16x16x32_bf16 v[124:127], v[76:79], v[60:63], v[124:127]
    v_mfma_f32_16x16x32_bf16 v[144:147], v[56:59], v[56:59], v[144:147]
    ds_read_b64_tr_b16 v[76:77], v14 offset:0
    ds_read_b64_tr_b16 v[78:79], v14 offset:1024
    s_waitcnt lgkmcnt(10)
    v_mfma_f32_16x16x32_bf16 v[100:103], v[80:83], v[56:59], v[100:103]
    v_mfma_f32_16x16x32_bf16 v[128:131], v[80:83], v[60:63], v[128:131]
    ds_read_b64_tr_b16 v[80:81], v15 offset:0
    ds_read_b64_tr_b16 v[82:83], v15 offset:1024
    s_waitcnt lgkmcnt(10)
    v_mfma_f32_16x16x32_bf16 v[104:107], v[64:67], v[56:59], v[104:107]
    v_mfma_f32_16x16x32_bf16 v[132:135], v[64:67], v[60:63], v[132:135]
    v_mfma_f32_16x16x32_bf16 v[140:143], v[36:39], v[56:59], v[140:143]
    ds_read_b64_tr_b16 v[64:65], v16 offset:0
    ds_read_b64_tr_b16 v[66:67], v16 offset:1024
    s_waitcnt lgkmcnt(8)
    v_mfma_f32_16x16x32_bf16 v[108:111], v[68:71], v[56:59], v[108:111]
    v_mfma_f32_16x16x32_bf16 v[136:139], v[68:71], v[60:63], v[136:139]
    s_barrier
    ds_read_b64_tr_b16 v[68:69], v17 offset:0
    ds_read_b64_tr_b16 v[70:71], v17 offset:1024
    s_waitcnt lgkmcnt(8)
    v_mfma_f32_16x16x32_bf16 v[84:87], v[72:75], v[48:51], v[84:87]
    v_mfma_f32_16x16x32_bf16 v[112:115], v[72:75], v[52:55], v[112:115]
    ds_read_b64_tr_b16 v[72:73], v18 offset:0
    ds_read_b64_tr_b16 v[74:75], v18 offset:1024
    s_waitcnt lgkmcnt(8)
    v_mfma_f32_16x16x32_bf16 v[88:91], v[76:79], v[48:51], v[88:91]
    v_mfma_f32_16x16x32_bf16 v[116:119], v[76:79], v[52:55], v[116:119]
    ds_read_b128 v[56:59], v43 offset:0
    ds_read_b128 v[60:63], v47 offset:0
    ds_read_b64_tr_b16 v[76:77], v19 offset:0
    ds_read_b64_tr_b16 v[78:79], v19 offset:1024
    s_waitcnt lgkmcnt(10)
    v_mfma_f32_16x16x32_bf16 v[92:95], v[80:83], v[48:51], v[92:95]
    v_mfma_f32_16x16x32_bf16 v[120:123], v[80:83], v[52:55], v[120:123]
    ds_read_b64_tr_b16 v[80:81], v13 offset:8192
    ds_read_b64_tr_b16 v[82:83], v13 offset:9216
    s_waitcnt lgkmcnt(10)
    v_mfma_f32_16x16x32_bf16 v[96:99], v[64:67], v[48:51], v[96:99]
    v_mfma_f32_16x16x32_bf16 v[124:127], v[64:67], v[52:55], v[124:127]
    v_mfma_f32_16x16x32_bf16 v[144:147], v[48:51], v[48:51], v[144:147]
    ds_read_b64_tr_b16 v[64:65], v14 offset:8192
    ds_read_b64_tr_b16 v[66:67], v14 offset:9216
    s_waitcnt lgkmcnt(10)
    v_mfma_f32_16x16x32_bf16 v[100:103], v[68:71], v[48:51], v[100:103]
    v_mfma_f32_16x16x32_bf16 v[128:131], v[68:71], v[52:55], v[128:131]
    ds_read_b64_tr_b16 v[68:69], v15 offset:8192
    ds_read_b64_tr_b16 v[70:71], v15 offset:9216
    s_waitcnt lgkmcnt(10)
    v_mfma_f32_16x16x32_bf16 v[104:107], v[72:75], v[48:51], v[104:107]
    v_mfma_f32_16x16x32_bf16 v[132:135], v[72:75], v[52:55], v[132:135]
    v_mfma_f32_16x16x32_bf16 v[140:143], v[36:39], v[48:51], v[140:143]
    ds_read_b64_tr_b16 v[72:73], v16 offset:8192
    ds_read_b64_tr_b16 v[74:75], v16 offset:9216
    s_waitcnt lgkmcnt(8)
    v_mfma_f32_16x16x32_bf16 v[108:111], v[76:79], v[48:51], v[108:111]
    v_mfma_f32_16x16x32_bf16 v[136:139], v[76:79], v[52:55], v[136:139]
    s_waitcnt vmcnt(0)
    s_barrier
    ds_read_b64_tr_b16 v[76:77], v17 offset:8192
    ds_read_b64_tr_b16 v[78:79], v17 offset:9216
    s_waitcnt lgkmcnt(8)
    v_mfma_f32_16x16x32_bf16 v[84:87], v[80:83], v[56:59], v[84:87]
    v_mfma_f32_16x16x32_bf16 v[112:115], v[80:83], v[60:63], v[112:115]
    ds_read_b64_tr_b16 v[80:81], v18 offset:8192
    ds_read_b64_tr_b16 v[82:83], v18 offset:9216
    s_waitcnt lgkmcnt(8)
    v_mfma_f32_16x16x32_bf16 v[88:91], v[64:67], v[56:59], v[88:91]
    v_mfma_f32_16x16x32_bf16 v[116:119], v[64:67], v[60:63], v[116:119]
    ds_read_b128 v[48:51], v40 offset:0
    ds_read_b128 v[52:55], v44 offset:0
    ds_read_b64_tr_b16 v[64:65], v19 offset:8192
    ds_read_b64_tr_b16 v[66:67], v19 offset:9216
    s_waitcnt lgkmcnt(10)
    v_mfma_f32_16x16x32_bf16 v[92:95], v[68:71], v[56:59], v[92:95]
    v_mfma_f32_16x16x32_bf16 v[120:123], v[68:71], v[60:63], v[120:123]
    ds_read_b64_tr_b16 v[68:69], v6 offset:0
    ds_read_b64_tr_b16 v[70:71], v6 offset:1024
    s_waitcnt lgkmcnt(10)
    v_mfma_f32_16x16x32_bf16 v[96:99], v[72:75], v[56:59], v[96:99]
    v_mfma_f32_16x16x32_bf16 v[124:127], v[72:75], v[60:63], v[124:127]
    v_mfma_f32_16x16x32_bf16 v[144:147], v[56:59], v[56:59], v[144:147]
    ds_read_b64_tr_b16 v[72:73], v7 offset:0
    ds_read_b64_tr_b16 v[74:75], v7 offset:1024
    s_waitcnt lgkmcnt(10)
    v_mfma_f32_16x16x32_bf16 v[100:103], v[76:79], v[56:59], v[100:103]
    v_mfma_f32_16x16x32_bf16 v[128:131], v[76:79], v[60:63], v[128:131]
    ds_read_b64_tr_b16 v[76:77], v8 offset:0
    ds_read_b64_tr_b16 v[78:79], v8 offset:1024
    s_waitcnt lgkmcnt(10)
    v_mfma_f32_16x16x32_bf16 v[104:107], v[80:83], v[56:59], v[104:107]
    v_mfma_f32_16x16x32_bf16 v[132:135], v[80:83], v[60:63], v[132:135]
    v_mfma_f32_16x16x32_bf16 v[140:143], v[36:39], v[56:59], v[140:143]
    ds_read_b64_tr_b16 v[80:81], v9 offset:0
    ds_read_b64_tr_b16 v[82:83], v9 offset:1024
    s_waitcnt lgkmcnt(8)
    v_mfma_f32_16x16x32_bf16 v[108:111], v[64:67], v[56:59], v[108:111]
    v_mfma_f32_16x16x32_bf16 v[136:139], v[64:67], v[60:63], v[136:139]
    s_barrier
    ds_read_b64_tr_b16 v[64:65], v10 offset:0
    ds_read_b64_tr_b16 v[66:67], v10 offset:1024
    s_waitcnt lgkmcnt(8)
    v_mfma_f32_16x16x32_bf16 v[84:87], v[68:71], v[48:51], v[84:87]
    v_mfma_f32_16x16x32_bf16 v[112:115], v[68:71], v[52:55], v[112:115]
    ds_read_b64_tr_b16 v[68:69], v11 offset:0
    ds_read_b64_tr_b16 v[70:71], v11 offset:1024
    s_waitcnt lgkmcnt(8)
    v_mfma_f32_16x16x32_bf16 v[88:91], v[72:75], v[48:51], v[88:91]
    v_mfma_f32_16x16x32_bf16 v[116:119], v[72:75], v[52:55], v[116:119]
    ds_read_b128 v[56:59], v41 offset:0
    ds_read_b128 v[60:63], v45 offset:0
    ds_read_b64_tr_b16 v[72:73], v12 offset:0
    ds_read_b64_tr_b16 v[74:75], v12 offset:1024
    s_waitcnt lgkmcnt(10)
    v_mfma_f32_16x16x32_bf16 v[92:95], v[76:79], v[48:51], v[92:95]
    v_mfma_f32_16x16x32_bf16 v[120:123], v[76:79], v[52:55], v[120:123]
    ds_read_b64_tr_b16 v[76:77], v6 offset:8192
    ds_read_b64_tr_b16 v[78:79], v6 offset:9216
    s_waitcnt lgkmcnt(10)
    v_mfma_f32_16x16x32_bf16 v[96:99], v[80:83], v[48:51], v[96:99]
    v_mfma_f32_16x16x32_bf16 v[124:127], v[80:83], v[52:55], v[124:127]
    v_mfma_f32_16x16x32_bf16 v[144:147], v[48:51], v[48:51], v[144:147]
    ds_read_b64_tr_b16 v[80:81], v7 offset:8192
    ds_read_b64_tr_b16 v[82:83], v7 offset:9216
    s_waitcnt lgkmcnt(10)
    v_mfma_f32_16x16x32_bf16 v[100:103], v[64:67], v[48:51], v[100:103]
    v_mfma_f32_16x16x32_bf16 v[128:131], v[64:67], v[52:55], v[128:131]
    ds_read_b64_tr_b16 v[64:65], v8 offset:8192
    ds_read_b64_tr_b16 v[66:67], v8 offset:9216
    s_waitcnt lgkmcnt(10)
    v_mfma_f32_16x16x32_bf16 v[104:107], v[68:71], v[48:51], v[104:107]
    v_mfma_f32_16x16x32_bf16 v[132:135], v[68:71], v[52:55], v[132:135]
    v_mfma_f32_16x16x32_bf16 v[140:143], v[36:39], v[48:51], v[140:143]
    ds_read_b64_tr_b16 v[68:69], v9 offset:8192
    ds_read_b64_tr_b16 v[70:71], v9 offset:9216
    s_waitcnt lgkmcnt(8)
    v_mfma_f32_16x16x32_bf16 v[108:111], v[72:75], v[48:51], v[108:111]
    v_mfma_f32_16x16x32_bf16 v[136:139], v[72:75], v[52:55], v[136:139]
    ds_read_b64_tr_b16 v[72:73], v10 offset:8192
    ds_read_b64_tr_b16 v[74:75], v10 offset:9216
    s_waitcnt lgkmcnt(8)
    v_mfma_f32_16x16x32_bf16 v[84:87], v[76:79], v[56:59], v[84:87]
    v_mfma_f32_16x16x32_bf16 v[112:115], v[76:79], v[60:63], v[112:115]
    ds_read_b64_tr_b16 v[76:77], v11 offset:8192
    ds_read_b64_tr_b16 v[78:79], v11 offset:9216
    s_waitcnt lgkmcnt(8)
    v_mfma_f32_16x16x32_bf16 v[88:91], v[80:83], v[56:59], v[88:91]
    v_mfma_f32_16x16x32_bf16 v[116:119], v[80:83], v[60:63], v[116:119]
    ds_read_b64_tr_b16 v[80:81], v12 offset:8192
    ds_read_b64_tr_b16 v[82:83], v12 offset:9216
    s_waitcnt lgkmcnt(8)
    v_mfma_f32_16x16x32_bf16 v[92:95], v[64:67], v[56:59], v[92:95]
    v_mfma_f32_16x16x32_bf16 v[120:123], v[64:67], v[60:63], v[120:123]
    s_waitcnt lgkmcnt(6)
    v_mfma_f32_16x16x32_bf16 v[96:99], v[68:71], v[56:59], v[96:99]
    v_mfma_f32_16x16x32_bf16 v[124:127], v[68:71], v[60:63], v[124:127]
    v_mfma_f32_16x16x32_bf16 v[144:147], v[56:59], v[56:59], v[144:147]
    s_waitcnt lgkmcnt(4)
    v_mfma_f32_16x16x32_bf16 v[100:103], v[72:75], v[56:59], v[100:103]
    v_mfma_f32_16x16x32_bf16 v[128:131], v[72:75], v[60:63], v[128:131]
    s_waitcnt lgkmcnt(2)
    v_mfma_f32_16x16x32_bf16 v[104:107], v[76:79], v[56:59], v[104:107]
    v_mfma_f32_16x16x32_bf16 v[132:135], v[76:79], v[60:63], v[132:135]
    v_mfma_f32_16x16x32_bf16 v[140:143], v[36:39], v[56:59], v[140:143]
    s_waitcnt lgkmcnt(0)
    v_mfma_f32_16x16x32_bf16 v[108:111], v[80:83], v[56:59], v[108:111]
    v_mfma_f32_16x16x32_bf16 v[136:139], v[80:83], v[60:63], v[136:139]
    s_nop 7
    s_nop 3
    v_and_b32 v36, 3, v2
    v_mov_b32 v37, v144
    v_cmp_eq_u32 vcc, 1, v36
    s_nop 1
    v_cndmask_b32 v37, v37, v145, vcc
    v_cmp_eq_u32 vcc, 2, v36
    s_nop 1
    v_cndmask_b32 v37, v37, v146, vcc
    v_cmp_eq_u32 vcc, 3, v36
    s_nop 1
    v_cndmask_b32 v37, v37, v147, vcc
    v_lshrrev_b32 v36, 2, v2
    v_lshl_add_u32 v36, v36, 4, v2
    v_lshlrev_b32 v36, 2, v36
    ds_bpermute_b32 v38, v36, v37
    s_waitcnt lgkmcnt(0)
    v_mul_f32 v36, 0x3acccccd, v140
    v_mul_f32 v38, 0x3acccccd, v38
    v_fma_f32 v38, -v36, v36, v38
    v_max_f32 v38, 0, v38
    v_mov_b32 v39, v36
    v_cvt_pk_bf16_f32 v39, v39, v39
    v_lshlrev_b32 v39, 16, v39
    v_mov_b32 v37, v38
    v_cvt_pk_bf16_f32 v37, v37, v37
    v_lshlrev_b32 v37, 16, v37
    v_add_f32 v37, 0x3727c5ac, v37
    v_cvt_pk_bf16_f32 v37, v37, v37
    v_lshlrev_b32 v37, 16, v37
    v_sqrt_f32 v37, v37
    s_nop 0
    v_cvt_pk_bf16_f32 v37, v37, v37
    v_lshlrev_b32 v37, 16, v37
    v_rcp_f32 v40, v37
    v_sub_f32 v36, v36, v39
    v_mul_f32 v36, v36, v40
    v_cvt_pk_bf16_f32 v36, v36, v36
    v_lshlrev_b32 v36, 16, v36
    v_mul_f32 v37, v40, v40
    v_mul_f32 v37, v37, v38
    v_cvt_pk_bf16_f32 v37, v37, v37
    v_lshlrev_b32 v37, 16, v37
    v_add_f32 v37, 0x3727c5ac, v37
    v_cvt_pk_bf16_f32 v37, v37, v37
    v_lshlrev_b32 v37, 16, v37
    v_sqrt_f32 v37, v37
    s_nop 0
    v_cvt_pk_bf16_f32 v37, v37, v37
    v_lshlrev_b32 v37, 16, v37
    v_rcp_f32 v37, v37
    v_mul_f32 v41, v40, v39
    v_add_f32 v36, v36, v41
    v_mul_f32 v42, v40, v37
    v_mul_f32 v43, v36, v37
    s_lshl_b32 s46, s43, 5
    s_lshl_b32 s47, s44, 4
    s_add_u32 s48, s46, s47
    s_add_u32 s48, s48, 16
    s_sub_u32 s49, s46, s47
    s_add_u32 s49, s49, 32
    v_add_u32 v48, s48, v2
    v_add_u32 v49, s49, v2
    v_lshlrev_b32 v50, 4, v48
    v_lshlrev_b32 v51, 4, v49
    v_add_u32 v50, 0x25800, v50
    v_add_u32 v51, 0x25800, v51
    ds_write_b128 v50, v[40:43]
    s_waitcnt lgkmcnt(0)
    s_barrier
    ds_read_b128 v[44:47], v51
    s_lshl_b32 s46, s44, 8
    s_add_u32 s46, s46, 0x26100
    v_lshl_add_u32 v36, v3, 4, s46
    ds_read_b128 v[52:55], v36 offset:0
    ds_read_b128 v[56:59], v36 offset:64
    ds_read_b128 v[60:63], v36 offset:128
    ds_read_b128 v[64:67], v36 offset:192
    s_mul_i32 s46, s44, 192
    s_add_u32 s46, s46, 0x26300
    v_lshl_add_u32 v37, v3, 4, s46
    ds_read_b128 v[68:71], v37 offset:0
    ds_read_b128 v[72:75], v37 offset:64
    ds_read_b128 v[76:79], v37 offset:128
    s_waitcnt lgkmcnt(0)
    v_mul_u32_u24 v4, 304, v48
    v_mul_u32_u24 v5, 304, v49
    s_lshl_b32 s46, s44, 4
    v_add_u32 v6, s46, v3
    v_add_u32 v36, 0, v6
    v_mul_u32_u24 v37, 52, v36
    v_lshrrev_b32 v37, 8, v37
    v_add_u32 v36, v36, v37
    v_pk_mul_f32 v[80:81], v[52:53], v[40:41] op_sel:[0,1] op_sel_hi:[1,1]
    v_pk_fma_f32 v[84:85], v[84:85], v[40:41], v[80:81] op_sel_hi:[1,0,1] neg_lo:[0,0,1] neg_hi:[0,0,1]
    v_pk_mul_f32 v[80:81], v[54:55], v[40:41] op_sel:[0,1] op_sel_hi:[1,1]
    v_pk_fma_f32 v[86:87], v[86:87], v[40:41], v[80:81] op_sel_hi:[1,0,1] neg_lo:[0,0,1] neg_hi:[0,0,1]
    v_cvt_pk_bf16_f32 v84, v84, v85
    v_cvt_pk_bf16_f32 v85, v86, v87
    v_lshl_add_u32 v38, v36, 3, v4
    ds_write_b64 v38, v[84:85]
    v_pk_mul_f32 v[80:81], v[52:53], v[44:45] op_sel:[0,1] op_sel_hi:[1,1]
    v_pk_fma_f32 v[112:113], v[112:113], v[44:45], v[80:81] op_sel_hi:[1,0,1] neg_lo:[0,0,1] neg_hi:[0,0,1]
    v_pk_mul_f32 v[80:81], v[54:55], v[44:45] op_sel:[0,1] op_sel_hi:[1,1]
    v_pk_fma_f32 v[114:115], v[114:115], v[44:45], v[80:81] op_sel_hi:[1,0,1] neg_lo:[0,0,1] neg_hi:[0,0,1]
    v_cvt_pk_bf16_f32 v112, v112, v113
    v_cvt_pk_bf16_f32 v113, v114, v115
    v_lshl_add_u32 v38, v36, 3, v5
    ds_write_b64 v38, v[112:113]
    v_add_u32 v36, 4, v6
    v_mul_u32_u24 v37, 52, v36
    v_lshrrev_b32 v37, 8, v37
    v_add_u32 v36, v36, v37
    v_pk_mul_f32 v[80:81], v[56:57], v[40:41] op_sel:[0,1] op_sel_hi:[1,1]
    v_pk_fma_f32 v[88:89], v[88:89], v[40:41], v[80:81] op_sel_hi:[1,0,1] neg_lo:[0,0,1] neg_hi:[0,0,1]
    v_pk_mul_f32 v[80:81], v[58:59], v[40:41] op_sel:[0,1] op_sel_hi:[1,1]
    v_pk_fma_f32 v[90:91], v[90:91], v[40:41], v[80:81] op_sel_hi:[1,0,1] neg_lo:[0,0,1] neg_hi:[0,0,1]
    v_cvt_pk_bf16_f32 v88, v88, v89
    v_cvt_pk_bf16_f32 v89, v90, v91
    v_lshl_add_u32 v38, v36, 3, v4
    ds_write_b64 v38, v[88:89]
    v_pk_mul_f32 v[80:81], v[56:57], v[44:45] op_sel:[0,1] op_sel_hi:[1,1]
    v_pk_fma_f32 v[116:117], v[116:117], v[44:45], v[80:81] op_sel_hi:[1,0,1] neg_lo:[0,0,1] neg_hi:[0,0,1]
    v_pk_mul_f32 v[80:81], v[58:59], v[44:45] op_sel:[0,1] op_sel_hi:[1,1]
    v_pk_fma_f32 v[118:119], v[118:119], v[44:45], v[80:81] op_sel_hi:[1,0,1] neg_lo:[0,0,1] neg_hi:[0,0,1]
    v_cvt_pk_bf16_f32 v116, v116, v117
    v_cvt_pk_bf16_f32 v117, v118, v119
    v_lshl_add_u32 v38, v36, 3, v5
    ds_write_b64 v38, v[116:117]
    v_add_u32 v36, 8, v6
    v_mul_u32_u24 v37, 52, v36
    v_lshrrev_b32 v37, 8, v37
    v_add_u32 v36, v36, v37
    v_pk_mul_f32 v[80:81], v[60:61], v[40:41] op_sel:[0,1] op_sel_hi:[1,1]
    v_pk_fma_f32 v[92:93], v[92:93], v[40:41], v[80:81] op_sel_hi:[1,0,1] neg_lo:[0,0,1] neg_hi:[0,0,1]
    v_pk_mul_f32 v[80:81], v[62:63], v[40:41] op_sel:[0,1] op_sel_hi:[1,1]
    v_pk_fma_f32 v[94:95], v[94:95], v[40:41], v[80:81] op_sel_hi:[1,0,1] neg_lo:[0,0,1] neg_hi:[0,0,1]
    v_cvt_pk_bf16_f32 v92, v92, v93
    v_cvt_pk_bf16_f32 v93, v94, v95
    v_lshl_add_u32 v38, v36, 3, v4
    ds_write_b64 v38, v[92:93]
    v_pk_mul_f32 v[80:81], v[60:61], v[44:45] op_sel:[0,1] op_sel_hi:[1,1]
    v_pk_fma_f32 v[120:121], v[120:121], v[44:45], v[80:81] op_sel_hi:[1,0,1] neg_lo:[0,0,1] neg_hi:[0,0,1]
    v_pk_mul_f32 v[80:81], v[62:63], v[44:45] op_sel:[0,1] op_sel_hi:[1,1]
    v_pk_fma_f32 v[122:123], v[122:123], v[44:45], v[80:81] op_sel_hi:[1,0,1] neg_lo:[0,0,1] neg_hi:[0,0,1]
    v_cvt_pk_bf16_f32 v120, v120, v121
    v_cvt_pk_bf16_f32 v121, v122, v123
    v_lshl_add_u32 v38, v36, 3, v5
    ds_write_b64 v38, v[120:121]
    v_add_u32 v36, 12, v6
    v_mul_u32_u24 v37, 52, v36
    v_lshrrev_b32 v37, 8, v37
    v_add_u32 v36, v36, v37
    v_pk_mul_f32 v[80:81], v[64:65], v[40:41] op_sel:[0,1] op_sel_hi:[1,1]
    v_pk_fma_f32 v[96:97], v[96:97], v[40:41], v[80:81] op_sel_hi:[1,0,1] neg_lo:[0,0,1] neg_hi:[0,0,1]
    v_pk_mul_f32 v[80:81], v[66:67], v[40:41] op_sel:[0,1] op_sel_hi:[1,1]
    v_pk_fma_f32 v[98:99], v[98:99], v[40:41], v[80:81] op_sel_hi:[1,0,1] neg_lo:[0,0,1] neg_hi:[0,0,1]
    v_cvt_pk_bf16_f32 v96, v96, v97
    v_cvt_pk_bf16_f32 v97, v98, v99
    v_lshl_add_u32 v38, v36, 3, v4
    ds_write_b64 v38, v[96:97]
    v_pk_mul_f32 v[80:81], v[64:65], v[44:45] op_sel:[0,1] op_sel_hi:[1,1]
    v_pk_fma_f32 v[124:125], v[124:125], v[44:45], v[80:81] op_sel_hi:[1,0,1] neg_lo:[0,0,1] neg_hi:[0,0,1]
    v_pk_mul_f32 v[80:81], v[66:67], v[44:45] op_sel:[0,1] op_sel_hi:[1,1]
    v_pk_fma_f32 v[126:127], v[126:127], v[44:45], v[80:81] op_sel_hi:[1,0,1] neg_lo:[0,0,1] neg_hi:[0,0,1]
    v_cvt_pk_bf16_f32 v124, v124, v125
    v_cvt_pk_bf16_f32 v125, v126, v127
    v_lshl_add_u32 v38, v36, 3, v5
    ds_write_b64 v38, v[124:125]
    s_mul_i32 s46, s41, 6
    s_mul_i32 s47, s44, 3
    s_add_u32 s46, s46, s47
    s_add_u32 s46, s46, 40
    s_add_u32 s47, s46, 0
    s_lshr_b32 s48, s47, 1
    s_lshl_b32 s48, s48, 12
    s_and_b32 s47, s47, 1
    s_lshl_b32 s47, s47, 9
    s_add_u32 s64, s47, s48
    s_add_u32 s47, s46, 1
    s_lshr_b32 s48, s47, 1
    s_lshl_b32 s48, s48, 12
    s_and_b32 s47, s47, 1
    s_lshl_b32 s47, s47, 9
    s_add_u32 s65, s47, s48
    s_add_u32 s47, s46, 2
    s_lshr_b32 s48, s47, 1
    s_lshl_b32 s48, s48, 12
    s_and_b32 s47, s47, 1
    s_lshl_b32 s47, s47, 9
    s_add_u32 s66, s47, s48
    s_lshl_b32 s47, s40, 1
    s_lshr_b32 s48, s43, 1
    s_add_u32 s47, s47, s48
    s_mul_i32 s47, s47, 278528
    s_and_b32 s48, s43, 1
    s_lshl_b32 s48, s48, 11
    s_add_u32 s47, s47, s48
    s_lshl_b32 s46, s44, 10
    s_add_u32 s48, s47, s46
    s_sub_u32 s49, s47, s46
    s_add_u32 s49, s49, 1024
    v_lshrrev_b32 v36, 1, v3
    v_lshlrev_b32 v36, 8, v36
    v_lshl_add_u32 v36, v2, 4, v36
    v_and_b32 v37, 1, v3
    v_lshl_add_u32 v36, v37, 3, v36
    v_add_u32 v38, s48, v36
    v_add_u32 v39, s49, v36
    v_mov_b32 v8, 0x40135761
    v_mov_b32 v9, 0x3dd2d3e8
    v_mov_b32 v10, 1.0
    v_mov_b32 v11, 1.0
    v_lshlrev_b32 v80, 16, v20
    v_and_b32 v81, 0xffff0000, v20
    v_lshlrev_b32 v82, 16, v21
    v_and_b32 v83, 0xffff0000, v21
    v_pk_fma_f32 v[4:5], v[68:69], v[42:43], v[80:81] op_sel:[0,1,0] op_sel_hi:[1,1,1] neg_lo:[0,1,0] neg_hi:[0,1,0]
    v_pk_fma_f32 v[6:7], v[70:71], v[42:43], v[82:83] op_sel:[0,1,0] op_sel_hi:[1,1,1] neg_lo:[0,1,0] neg_hi:[0,1,0]
    v_pk_fma_f32 v[100:101], v[100:101], v[42:43], v[4:5] op_sel_hi:[1,0,1]
    v_pk_fma_f32 v[102:103], v[102:103], v[42:43], v[6:7] op_sel_hi:[1,0,1]
    v_pk_mul_f32 v[4:5], v[100:101], v[100:101]
    v_pk_mul_f32 v[6:7], v[102:103], v[102:103]
    v_pk_fma_f32 v[4:5], v[4:5], v[8:9], v[8:9] op_sel:[0,1,0] op_sel_hi:[1,1,0]
    v_pk_fma_f32 v[6:7], v[6:7], v[8:9], v[8:9] op_sel:[0,1,0] op_sel_hi:[1,1,0]
    v_pk_mul_f32 v[4:5], v[100:101], v[4:5] neg_lo:[1,0] neg_hi:[1,0]
    v_pk_mul_f32 v[6:7], v[102:103], v[6:7] neg_lo:[1,0] neg_hi:[1,0]
    v_exp_f32 v4, v4
    v_exp_f32 v5, v5
    v_exp_f32 v6, v6
    v_exp_f32 v7, v7
    s_nop 0
    v_pk_add_f32 v[4:5], v[4:5], v[10:11]
    v_pk_add_f32 v[6:7], v[6:7], v[10:11]
    v_rcp_f32 v4, v4
    v_rcp_f32 v5, v5
    v_rcp_f32 v6, v6
    v_rcp_f32 v7, v7
    s_nop 0
    v_pk_mul_f32 v[100:101], v[100:101], v[4:5]
    v_pk_mul_f32 v[102:103], v[102:103], v[6:7]
    v_cvt_pk_bf16_f32 v100, v100, v101
    v_cvt_pk_bf16_f32 v101, v102, v103
    buffer_store_dwordx2 v[100:101], v38, s[24:27], s64 offen sc1
    v_pk_fma_f32 v[4:5], v[68:69], v[46:47], v[80:81] op_sel:[0,1,0] op_sel_hi:[1,1,1] neg_lo:[0,1,0] neg_hi:[0,1,0]
    v_pk_fma_f32 v[6:7], v[70:71], v[46:47], v[82:83] op_sel:[0,1,0] op_sel_hi:[1,1,1] neg_lo:[0,1,0] neg_hi:[0,1,0]
    v_pk_fma_f32 v[128:129], v[128:129], v[46:47], v[4:5] op_sel_hi:[1,0,1]
    v_pk_fma_f32 v[130:131], v[130:131], v[46:47], v[6:7] op_sel_hi:[1,0,1]
    v_pk_mul_f32 v[4:5], v[128:129], v[128:129]
    v_pk_mul_f32 v[6:7], v[130:131], v[130:131]
    v_pk_fma_f32 v[4:5], v[4:5], v[8:9], v[8:9] op_sel:[0,1,0] op_sel_hi:[1,1,0]
    v_pk_fma_f32 v[6:7], v[6:7], v[8:9], v[8:9] op_sel:[0,1,0] op_sel_hi:[1,1,0]
    v_pk_mul_f32 v[4:5], v[128:129], v[4:5] neg_lo:[1,0] neg_hi:[1,0]
    v_pk_mul_f32 v[6:7], v[130:131], v[6:7] neg_lo:[1,0] neg_hi:[1,0]
    v_exp_f32 v4, v4
    v_exp_f32 v5, v5
    v_exp_f32 v6, v6
    v_exp_f32 v7, v7
    s_nop 0
    v_pk_add_f32 v[4:5], v[4:5], v[10:11]
    v_pk_add_f32 v[6:7], v[6:7], v[10:11]
    v_rcp_f32 v4, v4
    v_rcp_f32 v5, v5
    v_rcp_f32 v6, v6
    v_rcp_f32 v7, v7
    s_nop 0
    v_pk_mul_f32 v[128:129], v[128:129], v[4:5]
    v_pk_mul_f32 v[130:131], v[130:131], v[6:7]
    v_cvt_pk_bf16_f32 v128, v128, v129
    v_cvt_pk_bf16_f32 v129, v130, v131
    buffer_store_dwordx2 v[128:129], v39, s[24:27], s64 offen sc1
    v_lshlrev_b32 v80, 16, v22
    v_and_b32 v81, 0xffff0000, v22
    v_lshlrev_b32 v82, 16, v23
    v_and_b32 v83, 0xffff0000, v23
    v_pk_fma_f32 v[4:5], v[72:73], v[42:43], v[80:81] op_sel:[0,1,0] op_sel_hi:[1,1,1] neg_lo:[0,1,0] neg_hi:[0,1,0]
    v_pk_fma_f32 v[6:7], v[74:75], v[42:43], v[82:83] op_sel:[0,1,0] op_sel_hi:[1,1,1] neg_lo:[0,1,0] neg_hi:[0,1,0]
    v_pk_fma_f32 v[104:105], v[104:105], v[42:43], v[4:5] op_sel_hi:[1,0,1]
    v_pk_fma_f32 v[106:107], v[106:107], v[42:43], v[6:7] op_sel_hi:[1,0,1]
    v_pk_mul_f32 v[4:5], v[104:105], v[104:105]
    v_pk_mul_f32 v[6:7], v[106:107], v[106:107]
    v_pk_fma_f32 v[4:5], v[4:5], v[8:9], v[8:9] op_sel:[0,1,0] op_sel_hi:[1,1,0]
    v_pk_fma_f32 v[6:7], v[6:7], v[8:9], v[8:9] op_sel:[0,1,0] op_sel_hi:[1,1,0]
    v_pk_mul_f32 v[4:5], v[104:105], v[4:5] neg_lo:[1,0] neg_hi:[1,0]
    v_pk_mul_f32 v[6:7], v[106:107], v[6:7] neg_lo:[1,0] neg_hi:[1,0]
    v_exp_f32 v4, v4
    v_exp_f32 v5, v5
    v_exp_f32 v6, v6
    v_exp_f32 v7, v7
    s_nop 0
    v_pk_add_f32 v[4:5], v[4:5], v[10:11]
    v_pk_add_f32 v[6:7], v[6:7], v[10:11]
    v_rcp_f32 v4, v4
    v_rcp_f32 v5, v5
    v_rcp_f32 v6, v6
    v_rcp_f32 v7, v7
    s_nop 0
    v_pk_mul_f32 v[104:105], v[104:105], v[4:5]
    v_pk_mul_f32 v[106:107], v[106:107], v[6:7]
    v_cvt_pk_bf16_f32 v104, v104, v105
    v_cvt_pk_bf16_f32 v105, v106, v107
    buffer_store_dwordx2 v[104:105], v38, s[24:27], s65 offen sc1
    v_pk_fma_f32 v[4:5], v[72:73], v[46:47], v[80:81] op_sel:[0,1,0] op_sel_hi:[1,1,1] neg_lo:[0,1,0] neg_hi:[0,1,0]
    v_pk_fma_f32 v[6:7], v[74:75], v[46:47], v[82:83] op_sel:[0,1,0] op_sel_hi:[1,1,1] neg_lo:[0,1,0] neg_hi:[0,1,0]
    v_pk_fma_f32 v[132:133], v[132:133], v[46:47], v[4:5] op_sel_hi:[1,0,1]
    v_pk_fma_f32 v[134:135], v[134:135], v[46:47], v[6:7] op_sel_hi:[1,0,1]
    v_pk_mul_f32 v[4:5], v[132:133], v[132:133]
    v_pk_mul_f32 v[6:7], v[134:135], v[134:135]
    v_pk_fma_f32 v[4:5], v[4:5], v[8:9], v[8:9] op_sel:[0,1,0] op_sel_hi:[1,1,0]
    v_pk_fma_f32 v[6:7], v[6:7], v[8:9], v[8:9] op_sel:[0,1,0] op_sel_hi:[1,1,0]
    v_pk_mul_f32 v[4:5], v[132:133], v[4:5] neg_lo:[1,0] neg_hi:[1,0]
    v_pk_mul_f32 v[6:7], v[134:135], v[6:7] neg_lo:[1,0] neg_hi:[1,0]
    v_exp_f32 v4, v4
    v_exp_f32 v5, v5
    v_exp_f32 v6, v6
    v_exp_f32 v7, v7
    s_nop 0
    v_pk_add_f32 v[4:5], v[4:5], v[10:11]
    v_pk_add_f32 v[6:7], v[6:7], v[10:11]
    v_rcp_f32 v4, v4
    v_rcp_f32 v5, v5
    v_rcp_f32 v6, v6
    v_rcp_f32 v7, v7
    s_nop 0
    v_pk_mul_f32 v[132:133], v[132:133], v[4:5]
    v_pk_mul_f32 v[134:135], v[134:135], v[6:7]
    v_cvt_pk_bf16_f32 v132, v132, v133
    v_cvt_pk_bf16_f32 v133, v134, v135
    buffer_store_dwordx2 v[132:133], v39, s[24:27], s65 offen sc1
    v_lshlrev_b32 v80, 16, v24
    v_and_b32 v81, 0xffff0000, v24
    v_lshlrev_b32 v82, 16, v25
    v_and_b32 v83, 0xffff0000, v25
    v_pk_fma_f32 v[4:5], v[76:77], v[42:43], v[80:81] op_sel:[0,1,0] op_sel_hi:[1,1,1] neg_lo:[0,1,0] neg_hi:[0,1,0]
    v_pk_fma_f32 v[6:7], v[78:79], v[42:43], v[82:83] op_sel:[0,1,0] op_sel_hi:[1,1,1] neg_lo:[0,1,0] neg_hi:[0,1,0]
    v_pk_fma_f32 v[108:109], v[108:109], v[42:43], v[4:5] op_sel_hi:[1,0,1]
    v_pk_fma_f32 v[110:111], v[110:111], v[42:43], v[6:7] op_sel_hi:[1,0,1]
    v_pk_mul_f32 v[4:5], v[108:109], v[108:109]
    v_pk_mul_f32 v[6:7], v[110:111], v[110:111]
    v_pk_fma_f32 v[4:5], v[4:5], v[8:9], v[8:9] op_sel:[0,1,0] op_sel_hi:[1,1,0]
    v_pk_fma_f32 v[6:7], v[6:7], v[8:9], v[8:9] op_sel:[0,1,0] op_sel_hi:[1,1,0]
    v_pk_mul_f32 v[4:5], v[108:109], v[4:5] neg_lo:[1,0] neg_hi:[1,0]
    v_pk_mul_f32 v[6:7], v[110:111], v[6:7] neg_lo:[1,0] neg_hi:[1,0]
    v_exp_f32 v4, v4
    v_exp_f32 v5, v5
    v_exp_f32 v6, v6
    v_exp_f32 v7, v7
    s_nop 0
    v_pk_add_f32 v[4:5], v[4:5], v[10:11]
    v_pk_add_f32 v[6:7], v[6:7], v[10:11]
    v_rcp_f32 v4, v4
    v_rcp_f32 v5, v5
    v_rcp_f32 v6, v6
    v_rcp_f32 v7, v7
    s_nop 0
    v_pk_mul_f32 v[108:109], v[108:109], v[4:5]
    v_pk_mul_f32 v[110:111], v[110:111], v[6:7]
    v_cvt_pk_bf16_f32 v108, v108, v109
    v_cvt_pk_bf16_f32 v109, v110, v111
    buffer_store_dwordx2 v[108:109], v38, s[24:27], s66 offen sc1
    v_pk_fma_f32 v[4:5], v[76:77], v[46:47], v[80:81] op_sel:[0,1,0] op_sel_hi:[1,1,1] neg_lo:[0,1,0] neg_hi:[0,1,0]
    v_pk_fma_f32 v[6:7], v[78:79], v[46:47], v[82:83] op_sel:[0,1,0] op_sel_hi:[1,1,1] neg_lo:[0,1,0] neg_hi:[0,1,0]
    v_pk_fma_f32 v[136:137], v[136:137], v[46:47], v[4:5] op_sel_hi:[1,0,1]
    v_pk_fma_f32 v[138:139], v[138:139], v[46:47], v[6:7] op_sel_hi:[1,0,1]
    v_pk_mul_f32 v[4:5], v[136:137], v[136:137]
    v_pk_mul_f32 v[6:7], v[138:139], v[138:139]
    v_pk_fma_f32 v[4:5], v[4:5], v[8:9], v[8:9] op_sel:[0,1,0] op_sel_hi:[1,1,0]
    v_pk_fma_f32 v[6:7], v[6:7], v[8:9], v[8:9] op_sel:[0,1,0] op_sel_hi:[1,1,0]
    v_pk_mul_f32 v[4:5], v[136:137], v[4:5] neg_lo:[1,0] neg_hi:[1,0]
    v_pk_mul_f32 v[6:7], v[138:139], v[6:7] neg_lo:[1,0] neg_hi:[1,0]
    v_exp_f32 v4, v4
    v_exp_f32 v5, v5
    v_exp_f32 v6, v6
    v_exp_f32 v7, v7
    s_nop 0
    v_pk_add_f32 v[4:5], v[4:5], v[10:11]
    v_pk_add_f32 v[6:7], v[6:7], v[10:11]
    v_rcp_f32 v4, v4
    v_rcp_f32 v5, v5
    v_rcp_f32 v6, v6
    v_rcp_f32 v7, v7
    s_nop 0
    v_pk_mul_f32 v[136:137], v[136:137], v[4:5]
    v_pk_mul_f32 v[138:139], v[138:139], v[6:7]
    v_cvt_pk_bf16_f32 v136, v136, v137
    v_cvt_pk_bf16_f32 v137, v138, v139
    buffer_store_dwordx2 v[136:137], v39, s[24:27], s66 offen sc1
    s_waitcnt lgkmcnt(0)
    s_barrier
    v_and_b32 v4, 1, v0
    v_bfe_u32 v5, v0, 1, 7
    v_lshrrev_b32 v6, 8, v0
    v_lshlrev_b32 v7, 3, v4
    v_sub_u32 v7, v5, v7
    v_add_u32 v7, 10, v7
    v_mul_u32_u24 v7, 304, v7
    v_mul_u32_u24 v8, 48, v6
    v_add_u32 v7, v7, v8
    v_add_u32 v9, 16, v5
    v_mul_u32_u24 v9, 304, v9
    v_add_u32 v9, v9, v8
    ds_read_b128 v[20:23], v9 offset:192
    ds_read_b128 v[24:27], v9 offset:208
    ds_read_b64 v[28:29], v9 offset:224
    ds_read_b128 v[32:35], v7 offset:1824
    ds_read_b128 v[36:39], v7 offset:1840
    ds_read_b64 v[40:41], v7 offset:1856
    ds_read_b128 v[44:47], v7 offset:1216
    ds_read_b128 v[48:51], v7 offset:1232
    ds_read_b64 v[52:53], v7 offset:1248
    ds_read_b128 v[56:59], v7 offset:608
    ds_read_b128 v[60:63], v7 offset:624
    ds_read_b64 v[64:65], v7 offset:640
    ds_read_b128 v[68:71], v7 offset:0
    ds_read_b128 v[72:75], v7 offset:16
    ds_read_b64 v[76:77], v7 offset:32
    s_waitcnt lgkmcnt(0)
    ds_read_b128 v[80:83], v7 offset:1920
    ds_read_b128 v[84:87], v7 offset:1936
    ds_read_b64 v[88:89], v7 offset:1952
    ds_read_b128 v[92:95], v7 offset:1312
    ds_read_b128 v[96:99], v7 offset:1328
    ds_read_b64 v[100:101], v7 offset:1344
    ds_read_b128 v[104:107], v7 offset:704
    ds_read_b128 v[108:111], v7 offset:720
    ds_read_b64 v[112:113], v7 offset:736
    ds_read_b128 v[116:119], v7 offset:96
    ds_read_b128 v[120:123], v7 offset:112
    ds_read_b64 v[124:125], v7 offset:128
    v_mov_b32 v10, 0
    v_mov_b32 v11, 0
    v_mov_b32 v12, 0
    v_mov_b32 v13, 0
    v_dot2_f32_bf16 v10, v20, v32, v10
    v_dot2_f32_bf16 v11, v20, v44, v11
    v_dot2_f32_bf16 v12, v20, v56, v12
    v_dot2_f32_bf16 v13, v20, v68, v13
    v_dot2_f32_bf16 v10, v21, v33, v10
    v_dot2_f32_bf16 v11, v21, v45, v11
    v_dot2_f32_bf16 v12, v21, v57, v12
    v_dot2_f32_bf16 v13, v21, v69, v13
    v_dot2_f32_bf16 v10, v22, v34, v10
    v_dot2_f32_bf16 v11, v22, v46, v11
    v_dot2_f32_bf16 v12, v22, v58, v12
    v_dot2_f32_bf16 v13, v22, v70, v13
    v_dot2_f32_bf16 v10, v23, v35, v10
    v_dot2_f32_bf16 v11, v23, v47, v11
    v_dot2_f32_bf16 v12, v23, v59, v12
    v_dot2_f32_bf16 v13, v23, v71, v13
    v_dot2_f32_bf16 v10, v24, v36, v10
    v_dot2_f32_bf16 v11, v24, v48, v11
    v_dot2_f32_bf16 v12, v24, v60, v12
    v_dot2_f32_bf16 v13, v24, v72, v13
    v_dot2_f32_bf16 v10, v25, v37, v10
    v_dot2_f32_bf16 v11, v25, v49, v11
    v_dot2_f32_bf16 v12, v25, v61, v12
    v_dot2_f32_bf16 v13, v25, v73, v13
    v_dot2_f32_bf16 v10, v26, v38, v10
    v_dot2_f32_bf16 v11, v26, v50, v11
    v_dot2_f32_bf16 v12, v26, v62, v12
    v_dot2_f32_bf16 v13, v26, v74, v13
    v_dot2_f32_bf16 v10, v27, v39, v10
    v_dot2_f32_bf16 v11, v27, v51, v11
    v_dot2_f32_bf16 v12, v27, v63, v12
    v_dot2_f32_bf16 v13, v27, v75, v13
    v_dot2_f32_bf16 v10, v28, v40, v10
    v_dot2_f32_bf16 v11, v28, v52, v11
    v_dot2_f32_bf16 v12, v28, v64, v12
    v_dot2_f32_bf16 v13, v28, v76, v13
    v_dot2_f32_bf16 v10, v29, v41, v10
    v_dot2_f32_bf16 v11, v29, v53, v11
    v_dot2_f32_bf16 v12, v29, v65, v12
    v_dot2_f32_bf16 v13, v29, v77, v13
    s_lshl_b32 s46, s40, 7
    v_add_u32 v14, s46, v5
    v_lshlrev_b32 v15, 3, v4
    v_sub_u32 v14, v14, v15
    v_mov_b32 v15, 0xce6e6b28
    v_mov_b32 v16, 0x3ea52b5c
    v_mul_f32 v10, v10, v16
    v_cmp_le_i32 vcc, 0, v14
    s_nop 1
    v_cndmask_b32 v10, v15, v10, vcc
    v_mul_f32 v11, v11, v16
    v_cmp_le_i32 vcc, 2, v14
    s_nop 1
    v_cndmask_b32 v11, v15, v11, vcc
    v_mul_f32 v12, v12, v16
    v_cmp_le_i32 vcc, 4, v14
    s_nop 1
    v_cndmask_b32 v12, v15, v12, vcc
    v_mul_f32 v13, v13, v16
    v_cmp_le_i32 vcc, 6, v14
    s_nop 1
    v_cndmask_b32 v13, v15, v13, vcc
    v_max_f32 v16, v10, v11
    v_max3_f32 v16, v16, v12, v13
    s_nop 1
    v_max_f32_dpp v17, v16, v16 quad_perm:[1,0,3,2] row_mask:0xf bank_mask:0xf
    v_sub_f32 v10, v10, v17
    v_exp_f32 v10, v10
    v_sub_f32 v11, v11, v17
    v_exp_f32 v11, v11
    v_sub_f32 v12, v12, v17
    v_exp_f32 v12, v12
    v_sub_f32 v13, v13, v17
    v_exp_f32 v13, v13
    s_nop 0
    v_add_f32 v16, v10, v11
    v_add_f32 v18, v12, v13
    v_add_f32 v16, v16, v18
    s_nop 1
    v_add_f32_dpp v17, v16, v16 quad_perm:[1,0,3,2] row_mask:0xf bank_mask:0xf
    v_rcp_f32 v17, v17
    s_nop 0
    v_mul_f32 v10, v10, v17
    v_cvt_pk_bf16_f32 v20, v10, 0
    v_lshlrev_b32 v24, 16, v20
    v_mul_f32 v11, v11, v17
    v_cvt_pk_bf16_f32 v21, v11, 0
    v_lshlrev_b32 v25, 16, v21
    v_mul_f32 v12, v12, v17
    v_cvt_pk_bf16_f32 v22, v12, 0
    v_lshlrev_b32 v26, 16, v22
    v_mul_f32 v13, v13, v17
    v_cvt_pk_bf16_f32 v23, v13, 0
    v_lshlrev_b32 v27, 16, v23
    s_waitcnt lgkmcnt(0)
    v_dot2_f32_bf16 v32, v80, v20, 0
    v_dot2_f32_bf16 v33, v80, v24, 0
    v_dot2_f32_bf16 v34, v81, v20, 0
    v_dot2_f32_bf16 v35, v81, v24, 0
    v_dot2_f32_bf16 v36, v82, v20, 0
    v_dot2_f32_bf16 v37, v82, v24, 0
    v_dot2_f32_bf16 v38, v83, v20, 0
    v_dot2_f32_bf16 v39, v83, v24, 0
    v_dot2_f32_bf16 v40, v84, v20, 0
    v_dot2_f32_bf16 v41, v84, v24, 0
    v_dot2_f32_bf16 v42, v85, v20, 0
    v_dot2_f32_bf16 v43, v85, v24, 0
    v_dot2_f32_bf16 v44, v86, v20, 0
    v_dot2_f32_bf16 v45, v86, v24, 0
    v_dot2_f32_bf16 v46, v87, v20, 0
    v_dot2_f32_bf16 v47, v87, v24, 0
    v_dot2_f32_bf16 v48, v88, v20, 0
    v_dot2_f32_bf16 v49, v88, v24, 0
    v_dot2_f32_bf16 v50, v89, v20, 0
    v_dot2_f32_bf16 v51, v89, v24, 0
    v_dot2_f32_bf16 v32, v92, v21, v32
    v_dot2_f32_bf16 v33, v92, v25, v33
    v_dot2_f32_bf16 v34, v93, v21, v34
    v_dot2_f32_bf16 v35, v93, v25, v35
    v_dot2_f32_bf16 v36, v94, v21, v36
    v_dot2_f32_bf16 v37, v94, v25, v37
    v_dot2_f32_bf16 v38, v95, v21, v38
    v_dot2_f32_bf16 v39, v95, v25, v39
    v_dot2_f32_bf16 v40, v96, v21, v40
    v_dot2_f32_bf16 v41, v96, v25, v41
    v_dot2_f32_bf16 v42, v97, v21, v42
    v_dot2_f32_bf16 v43, v97, v25, v43
    v_dot2_f32_bf16 v44, v98, v21, v44
    v_dot2_f32_bf16 v45, v98, v25, v45
    v_dot2_f32_bf16 v46, v99, v21, v46
    v_dot2_f32_bf16 v47, v99, v25, v47
    v_dot2_f32_bf16 v48, v100, v21, v48
    v_dot2_f32_bf16 v49, v100, v25, v49
    v_dot2_f32_bf16 v50, v101, v21, v50
    v_dot2_f32_bf16 v51, v101, v25, v51
    v_dot2_f32_bf16 v32, v104, v22, v32
    v_dot2_f32_bf16 v33, v104, v26, v33
    v_dot2_f32_bf16 v34, v105, v22, v34
    v_dot2_f32_bf16 v35, v105, v26, v35
    v_dot2_f32_bf16 v36, v106, v22, v36
    v_dot2_f32_bf16 v37, v106, v26, v37
    v_dot2_f32_bf16 v38, v107, v22, v38
    v_dot2_f32_bf16 v39, v107, v26, v39
    v_dot2_f32_bf16 v40, v108, v22, v40
    v_dot2_f32_bf16 v41, v108, v26, v41
    v_dot2_f32_bf16 v42, v109, v22, v42
    v_dot2_f32_bf16 v43, v109, v26, v43
    v_dot2_f32_bf16 v44, v110, v22, v44
    v_dot2_f32_bf16 v45, v110, v26, v45
    v_dot2_f32_bf16 v46, v111, v22, v46
    v_dot2_f32_bf16 v47, v111, v26, v47
    v_dot2_f32_bf16 v48, v112, v22, v48
    v_dot2_f32_bf16 v49, v112, v26, v49
    v_dot2_f32_bf16 v50, v113, v22, v50
    v_dot2_f32_bf16 v51, v113, v26, v51
    v_dot2_f32_bf16 v32, v116, v23, v32
    v_dot2_f32_bf16 v33, v116, v27, v33
    v_dot2_f32_bf16 v34, v117, v23, v34
    v_dot2_f32_bf16 v35, v117, v27, v35
    v_dot2_f32_bf16 v36, v118, v23, v36
    v_dot2_f32_bf16 v37, v118, v27, v37
    v_dot2_f32_bf16 v38, v119, v23, v38
    v_dot2_f32_bf16 v39, v119, v27, v39
    v_dot2_f32_bf16 v40, v120, v23, v40
    v_dot2_f32_bf16 v41, v120, v27, v41
    v_dot2_f32_bf16 v42, v121, v23, v42
    v_dot2_f32_bf16 v43, v121, v27, v43
    v_dot2_f32_bf16 v44, v122, v23, v44
    v_dot2_f32_bf16 v45, v122, v27, v45
    v_dot2_f32_bf16 v46, v123, v23, v46
    v_dot2_f32_bf16 v47, v123, v27, v47
    v_dot2_f32_bf16 v48, v124, v23, v48
    v_dot2_f32_bf16 v49, v124, v27, v49
    v_dot2_f32_bf16 v50, v125, v23, v50
    v_dot2_f32_bf16 v51, v125, v27, v51
    v_cmp_eq_u32 vcc, 1, v4
    s_nop 1
    v_cndmask_b32 v56, v32, v42, vcc
    v_cndmask_b32 v66, v42, v32, vcc
    v_cndmask_b32 v57, v33, v43, vcc
    v_cndmask_b32 v67, v43, v33, vcc
    v_cndmask_b32 v58, v34, v44, vcc
    v_cndmask_b32 v68, v44, v34, vcc
    v_cndmask_b32 v59, v35, v45, vcc
    v_cndmask_b32 v69, v45, v35, vcc
    v_cndmask_b32 v60, v36, v46, vcc
    v_cndmask_b32 v70, v46, v36, vcc
    v_cndmask_b32 v61, v37, v47, vcc
    v_cndmask_b32 v71, v47, v37, vcc
    v_cndmask_b32 v62, v38, v48, vcc
    v_cndmask_b32 v72, v48, v38, vcc
    v_cndmask_b32 v63, v39, v49, vcc
    v_cndmask_b32 v73, v49, v39, vcc
    v_cndmask_b32 v64, v40, v50, vcc
    v_cndmask_b32 v74, v50, v40, vcc
    v_cndmask_b32 v65, v41, v51, vcc
    v_cndmask_b32 v75, v51, v41, vcc
    s_nop 1
    v_add_f32_dpp v56, v66, v56 quad_perm:[1,0,3,2] row_mask:0xf bank_mask:0xf
    v_add_f32_dpp v57, v67, v57 quad_perm:[1,0,3,2] row_mask:0xf bank_mask:0xf
    v_add_f32_dpp v58, v68, v58 quad_perm:[1,0,3,2] row_mask:0xf bank_mask:0xf
    v_add_f32_dpp v59, v69, v59 quad_perm:[1,0,3,2] row_mask:0xf bank_mask:0xf
    v_add_f32_dpp v60, v70, v60 quad_perm:[1,0,3,2] row_mask:0xf bank_mask:0xf
    v_add_f32_dpp v61, v71, v61 quad_perm:[1,0,3,2] row_mask:0xf bank_mask:0xf
    v_add_f32_dpp v62, v72, v62 quad_perm:[1,0,3,2] row_mask:0xf bank_mask:0xf
    v_add_f32_dpp v63, v73, v63 quad_perm:[1,0,3,2] row_mask:0xf bank_mask:0xf
    v_add_f32_dpp v64, v74, v64 quad_perm:[1,0,3,2] row_mask:0xf bank_mask:0xf
    v_add_f32_dpp v65, v75, v65 quad_perm:[1,0,3,2] row_mask:0xf bank_mask:0xf
    v_cvt_pk_bf16_f32 v76, v56, v57
    v_cvt_pk_bf16_f32 v77, v58, v59
    v_cvt_pk_bf16_f32 v78, v60, v61
    v_cvt_pk_bf16_f32 v79, v62, v63
    v_cvt_pk_bf16_f32 v80, v64, v65
    v_lshrrev_b32 v14, 6, v5
    s_lshl_b32 s47, s40, 1
    v_add_u32 v14, s47, v14
    s_mov_b32 s48, 278528
    v_mul_lo_u32 v14, v14, s48
    v_bfe_u32 v15, v5, 4, 2
    v_lshl_add_u32 v14, v15, 10, v14
    v_and_b32 v15, 15, v5
    v_lshl_add_u32 v14, v15, 4, v14
    s_mul_i32 s47, s41, 5
    v_lshl_add_u32 v15, v6, 1, v4
    v_add_u32 v16, s47, v15
    v_lshrrev_b32 v17, 2, v16
    v_lshl_add_u32 v17, v17, 12, v14
    v_and_b32 v16, 3, v16
    v_lshl_add_u32 v16, v16, 8, v17
    s_add_u32 s47, s47, 4
    s_lshr_b32 s48, s47, 2
    s_lshl_b32 s48, s48, 12
    s_and_b32 s47, s47, 3
    s_lshl_b32 s47, s47, 8
    s_add_u32 s47, s47, s48
    v_lshl_add_u32 v17, v15, 2, v14
    buffer_store_dwordx4 v[76:79], v16, s[24:27], 0 offen sc1
    buffer_store_dword v80, v17, s[24:27], s47 offen sc1
    s_endpgm
k1_extra:
    s_mov_b32 s46, 0x8000
    v_add_u32 v40, s46, v29
    v_xor_b32 v41, 64, v40
    v_add_u32 v42, 0x19000, v40
    v_add_u32 v43, 0x19000, v41
    s_lshl_b32 s46, s45, 2
    s_add_u32 s46, s46, 0
    s_cmp_lt_u32 s46, 14
    s_cselect_b32 s46, s46, 0
    s_and_b32 s47, s46, 7
    s_lshl_b32 s47, s47, 1
    s_lshr_b32 s46, s46, 3
    s_lshl_b32 s46, s46, 14
    v_add_u32 v35, s47, v34
    v_xor_b32 v35, v35, v32
    v_lshl_add_u32 v6, v35, 4, v33
    v_add_u32 v6, s46, v6
    v_add_u32 v13, 0x19000, v6
    s_lshl_b32 s46, s45, 2
    s_add_u32 s46, s46, 1
    s_cmp_lt_u32 s46, 14
    s_cselect_b32 s46, s46, 0
    s_and_b32 s47, s46, 7
    s_lshl_b32 s47, s47, 1
    s_lshr_b32 s46, s46, 3
    s_lshl_b32 s46, s46, 14
    v_add_u32 v35, s47, v34
    v_xor_b32 v35, v35, v32
    v_lshl_add_u32 v7, v35, 4, v33
    v_add_u32 v7, s46, v7
    v_add_u32 v14, 0x19000, v7
    s_lshl_b32 s46, s45, 2
    s_add_u32 s46, s46, 2
    s_cmp_lt_u32 s46, 14
    s_cselect_b32 s46, s46, 0
    s_and_b32 s47, s46, 7
    s_lshl_b32 s47, s47, 1
    s_lshr_b32 s46, s46, 3
    s_lshl_b32 s46, s46, 14
    v_add_u32 v35, s47, v34
    v_xor_b32 v35, v35, v32
    v_lshl_add_u32 v8, v35, 4, v33
    v_add_u32 v8, s46, v8
    v_add_u32 v15, 0x19000, v8
    s_lshl_b32 s46, s45, 2
    s_add_u32 s46, s46, 3
    s_cmp_lt_u32 s46, 14
    s_cselect_b32 s46, s46, 0
    s_and_b32 s47, s46, 7
    s_lshl_b32 s47, s47, 1
    s_lshr_b32 s46, s46, 3
    s_lshl_b32 s46, s46, 14
    v_add_u32 v35, s47, v34
    v_xor_b32 v35, v35, v32
    v_lshl_add_u32 v9, v35, 4, v33
    v_add_u32 v9, s46, v9
    v_add_u32 v16, 0x19000, v9
    v_mov_b32 v96, 0x3f803f80
    v_mov_b32 v97, 0x3f803f80
    v_mov_b32 v98, 0x3f803f80
    v_mov_b32 v99, 0x3f803f80
    v_mov_b32 v72, 0
    v_mov_b32 v73, 0
    v_mov_b32 v74, 0
    v_mov_b32 v75, 0
    v_mov_b32 v76, 0
    v_mov_b32 v77, 0
    v_mov_b32 v78, 0
    v_mov_b32 v79, 0
    v_mov_b32 v80, 0
    v_mov_b32 v81, 0
    v_mov_b32 v82, 0
    v_mov_b32 v83, 0
    v_mov_b32 v84, 0
    v_mov_b32 v85, 0
    v_mov_b32 v86, 0
    v_mov_b32 v87, 0
    v_mov_b32 v88, 0
    v_mov_b32 v89, 0
    v_mov_b32 v90, 0
    v_mov_b32 v91, 0
    v_mov_b32 v92, 0
    v_mov_b32 v93, 0
    v_mov_b32 v94, 0
    v_mov_b32 v95, 0
    v_cmp_eq_u32 s[38:39], 0, v2
    s_cmp_eq_u32 s45, 3
    s_cselect_b64 vcc, -1, 0
    s_waitcnt vmcnt(4)
    s_barrier
    ds_read_b128 v[44:47], v40 offset:0
    ds_read_b64_tr_b16 v[52:53], v6 offset:0
    ds_read_b64_tr_b16 v[54:55], v6 offset:1024
    ds_read_b64_tr_b16 v[56:57], v7 offset:0
    ds_read_b64_tr_b16 v[58:59], v7 offset:1024
    ds_read_b64_tr_b16 v[60:61], v8 offset:0
    ds_read_b64_tr_b16 v[62:63], v8 offset:1024
    ds_read_b64_tr_b16 v[64:65], v9 offset:0
    ds_read_b64_tr_b16 v[66:67], v9 offset:1024
    s_waitcnt lgkmcnt(8)
    v_cndmask_b32 v44, v44, v96, s[38:39]
    v_cndmask_b32 v45, v45, v96, s[38:39]
    v_cndmask_b32 v46, v46, v96, s[38:39]
    v_cndmask_b32 v47, v47, v96, s[38:39]
    ds_read_b128 v[48:51], v41 offset:0
    s_nop 0
    s_waitcnt lgkmcnt(7)
    v_mfma_f32_16x16x32_bf16 v[72:75], v[52:55], v[44:47], v[72:75]
    ds_read_b64_tr_b16 v[68:69], v6 offset:8192
    ds_read_b64_tr_b16 v[70:71], v6 offset:9216
    s_add_u32 m0, s70, 0x19000
    s_nop 0
    buffer_load_dwordx4 v160, s[64:67], s68 offen lds
    s_add_u32 s68, s68, s69
    s_cmp_eq_u32 s68, s71
    s_cselect_b32 s68, 0, s68
    s_waitcnt lgkmcnt(7)
    v_mfma_f32_16x16x32_bf16 v[76:79], v[56:59], v[44:47], v[76:79]
    ds_read_b64_tr_b16 v[52:53], v7 offset:8192
    ds_read_b64_tr_b16 v[54:55], v7 offset:9216
    s_add_u32 m0, s78, 0x19000
    s_nop 0
    buffer_load_dwordx4 v161, s[72:75], s76 offen lds
    s_add_u32 s76, s76, s77
    s_cmp_eq_u32 s76, s79
    s_cselect_b32 s76, 0, s76
    s_waitcnt lgkmcnt(7)
    s_cbranch_vccnz k1_xq10
    v_mfma_f32_16x16x32_bf16 v[80:83], v[60:63], v[44:47], v[80:83]
    s_branch k1_xr10
k1_xq10:
    v_mfma_f32_16x16x32_bf16 v[92:95], v[44:47], v[44:47], v[92:95]
k1_xr10:
    ds_read_b64_tr_b16 v[56:57], v8 offset:8192
    ds_read_b64_tr_b16 v[58:59], v8 offset:9216
    s_add_u32 m0, s86, 0x19000
    s_nop 0
    buffer_load_dwordx4 v162, s[80:83], s84 offen lds
    s_add_u32 s84, s84, s85
    s_cmp_eq_u32 s84, s87
    s_cselect_b32 s84, 0, s84
    s_waitcnt lgkmcnt(7)
    s_cbranch_vccnz k1_xq11
    v_mfma_f32_16x16x32_bf16 v[84:87], v[64:67], v[44:47], v[84:87]
    s_branch k1_xr11
k1_xq11:
    v_mfma_f32_16x16x32_bf16 v[88:91], v[96:99], v[44:47], v[88:91]
k1_xr11:
    ds_read_b64_tr_b16 v[60:61], v9 offset:8192
    ds_read_b64_tr_b16 v[62:63], v9 offset:9216
    s_add_u32 m0, s94, 0x19000
    s_nop 0
    buffer_load_dwordx4 v163, s[88:91], s92 offen lds
    s_add_u32 s92, s92, s93
    s_cmp_eq_u32 s92, s95
    s_cselect_b32 s92, 0, s92
    s_waitcnt vmcnt(4)
    s_barrier
    s_waitcnt lgkmcnt(8)
    v_cndmask_b32 v48, v48, v96, s[38:39]
    v_cndmask_b32 v49, v49, v96, s[38:39]
    v_cndmask_b32 v50, v50, v96, s[38:39]
    v_cndmask_b32 v51, v51, v96, s[38:39]
    ds_read_b128 v[44:47], v40 offset:51200
    s_nop 0
    s_waitcnt lgkmcnt(7)
    v_mfma_f32_16x16x32_bf16 v[72:75], v[68:71], v[48:51], v[72:75]
    ds_read_b64_tr_b16 v[64:65], v6 offset:51200
    ds_read_b64_tr_b16 v[66:67], v6 offset:52224
    s_waitcnt lgkmcnt(7)
    v_mfma_f32_16x16x32_bf16 v[76:79], v[52:55], v[48:51], v[76:79]
    ds_read_b64_tr_b16 v[68:69], v7 offset:51200
    ds_read_b64_tr_b16 v[70:71], v7 offset:52224
    s_waitcnt lgkmcnt(7)
    s_cbranch_vccnz k1_xq12
    v_mfma_f32_16x16x32_bf16 v[80:83], v[56:59], v[48:51], v[80:83]
    s_branch k1_xr12
k1_xq12:
    v_mfma_f32_16x16x32_bf16 v[92:95], v[48:51], v[48:51], v[92:95]
k1_xr12:
    ds_read_b64_tr_b16 v[52:53], v8 offset:51200
    ds_read_b64_tr_b16 v[54:55], v8 offset:52224
    s_waitcnt lgkmcnt(7)
    s_cbranch_vccnz k1_xq13
    v_mfma_f32_16x16x32_bf16 v[84:87], v[60:63], v[48:51], v[84:87]
    s_branch k1_xr13
k1_xq13:
    v_mfma_f32_16x16x32_bf16 v[88:91], v[96:99], v[48:51], v[88:91]
k1_xr13:
    ds_read_b64_tr_b16 v[56:57], v9 offset:51200
    ds_read_b64_tr_b16 v[58:59], v9 offset:52224
    s_barrier
    s_waitcnt lgkmcnt(8)
    v_cndmask_b32 v44, v44, v96, s[38:39]
    v_cndmask_b32 v45, v45, v96, s[38:39]
    v_cndmask_b32 v46, v46, v96, s[38:39]
    v_cndmask_b32 v47, v47, v96, s[38:39]
    ds_read_b128 v[48:51], v41 offset:51200
    s_nop 0
    s_waitcnt lgkmcnt(7)
    v_mfma_f32_16x16x32_bf16 v[72:75], v[64:67], v[44:47], v[72:75]
    ds_read_b64_tr_b16 v[60:61], v6 offset:59392
    ds_read_b64_tr_b16 v[62:63], v6 offset:60416
    s_add_u32 m0, s70, 0x0
    s_nop 0
    buffer_load_dwordx4 v160, s[64:67], s68 offen lds
    s_add_u32 s68, s68, s69
    s_cmp_eq_u32 s68, s71
    s_cselect_b32 s68, 0, s68
    s_waitcnt lgkmcnt(7)
    v_mfma_f32_16x16x32_bf16 v[76:79], v[68:71], v[44:47], v[76:79]
    ds_read_b64_tr_b16 v[64:65], v7 offset:59392
    ds_read_b64_tr_b16 v[66:67], v7 offset:60416
    s_add_u32 m0, s78, 0x0
    s_nop 0
    buffer_load_dwordx4 v161, s[72:75], s76 offen lds
    s_add_u32 s76, s76, s77
    s_cmp_eq_u32 s76, s79
    s_cselect_b32 s76, 0, s76
    s_waitcnt lgkmcnt(7)
    s_cbranch_vccnz k1_xq14
    v_mfma_f32_16x16x32_bf16 v[80:83], v[52:55], v[44:47], v[80:83]
    s_branch k1_xr14
k1_xq14:
    v_mfma_f32_16x16x32_bf16 v[92:95], v[44:47], v[44:47], v[92:95]
k1_xr14:
    ds_read_b64_tr_b16 v[68:69], v8 offset:59392
    ds_read_b64_tr_b16 v[70:71], v8 offset:60416
    s_add_u32 m0, s86, 0x0
    s_nop 0
    buffer_load_dwordx4 v162, s[80:83], s84 offen lds
    s_add_u32 s84, s84, s85
    s_cmp_eq_u32 s84, s87
    s_cselect_b32 s84, 0, s84
    s_waitcnt lgkmcnt(7)
    s_cbranch_vccnz k1_xq15
    v_mfma_f32_16x16x32_bf16 v[84:87], v[56:59], v[44:47], v[84:87]
    s_branch k1_xr15
k1_xq15:
    v_mfma_f32_16x16x32_bf16 v[88:91], v[96:99], v[44:47], v[88:91]
k1_xr15:
    ds_read_b64_tr_b16 v[52:53], v9 offset:59392
    ds_read_b64_tr_b16 v[54:55], v9 offset:60416
    s_add_u32 m0, s94, 0x0
    s_nop 0
    buffer_load_dwordx4 v163, s[88:91], s92 offen lds
    s_add_u32 s92, s92, s93
    s_cmp_eq_u32 s92, s95
    s_cselect_b32 s92, 0, s92
    s_waitcnt vmcnt(4)
    s_barrier
    s_waitcnt lgkmcnt(8)
    v_cndmask_b32 v48, v48, v96, s[38:39]
    v_cndmask_b32 v49, v49, v96, s[38:39]
    v_cndmask_b32 v50, v50, v96, s[38:39]
    v_cndmask_b32 v51, v51, v96, s[38:39]
    ds_read_b128 v[44:47], v42 offset:0
    s_nop 0
    s_waitcnt lgkmcnt(7)
    v_mfma_f32_16x16x32_bf16 v[72:75], v[60:63], v[48:51], v[72:75]
    ds_read_b64_tr_b16 v[56:57], v13 offset:0
    ds_read_b64_tr_b16 v[58:59], v13 offset:1024
    s_waitcnt lgkmcnt(7)
    v_mfma_f32_16x16x32_bf16 v[76:79], v[64:67], v[48:51], v[76:79]
    ds_read_b64_tr_b16 v[60:61], v14 offset:0
    ds_read_b64_tr_b16 v[62:63], v14 offset:1024
    s_waitcnt lgkmcnt(7)
    s_cbranch_vccnz k1_xq16
    v_mfma_f32_16x16x32_bf16 v[80:83], v[68:71], v[48:51], v[80:83]
    s_branch k1_xr16
k1_xq16:
    v_mfma_f32_16x16x32_bf16 v[92:95], v[48:51], v[48:51], v[92:95]
k1_xr16:
    ds_read_b64_tr_b16 v[64:65], v15 offset:0
    ds_read_b64_tr_b16 v[66:67], v15 offset:1024
    s_waitcnt lgkmcnt(7)
    s_cbranch_vccnz k1_xq17
    v_mfma_f32_16x16x32_bf16 v[84:87], v[52:55], v[48:51], v[84:87]
    s_branch k1_xr17
k1_xq17:
    v_mfma_f32_16x16x32_bf16 v[88:91], v[96:99], v[48:51], v[88:91]
k1_xr17:
    ds_read_b64_tr_b16 v[68:69], v16 offset:0
    ds_read_b64_tr_b16 v[70:71], v16 offset:1024
    s_barrier
    s_waitcnt lgkmcnt(8)
    v_cndmask_b32 v44, v44, v96, s[38:39]
    v_cndmask_b32 v45, v45, v96, s[38:39]
    v_cndmask_b32 v46, v46, v96, s[38:39]
    v_cndmask_b32 v47, v47, v96, s[38:39]
    ds_read_b128 v[48:51], v43 offset:0
    s_nop 0
    s_waitcnt lgkmcnt(7)
    v_mfma_f32_16x16x32_bf16 v[72:75], v[56:59], v[44:47], v[72:75]
    ds_read_b64_tr_b16 v[52:53], v13 offset:8192
    ds_read_b64_tr_b16 v[54:55], v13 offset:9216
    s_add_u32 m0, s70, 0xc800
    s_nop 0
    buffer_load_dwordx4 v160, s[64:67], s68 offen lds
    s_add_u32 s68, s68, s69
    s_cmp_eq_u32 s68, s71
    s_cselect_b32 s68, 0, s68
    s_waitcnt lgkmcnt(7)
    v_mfma_f32_16x16x32_bf16 v[76:79], v[60:63], v[44:47], v[76:79]
    ds_read_b64_tr_b16 v[56:57], v14 offset:8192
    ds_read_b64_tr_b16 v[58:59], v14 offset:9216
    s_add_u32 m0, s78, 0xc800
    s_nop 0
    buffer_load_dwordx4 v161, s[72:75], s76 offen lds
    s_add_u32 s76, s76, s77
    s_cmp_eq_u32 s76, s79
    s_cselect_b32 s76, 0, s76
    s_waitcnt lgkmcnt(7)
    s_cbranch_vccnz k1_xq18
    v_mfma_f32_16x16x32_bf16 v[80:83], v[64:67], v[44:47], v[80:83]
    s_branch k1_xr18
k1_xq18:
    v_mfma_f32_16x16x32_bf16 v[92:95], v[44:47], v[44:47], v[92:95]
k1_xr18:
    ds_read_b64_tr_b16 v[60:61], v15 offset:8192
    ds_read_b64_tr_b16 v[62:63], v15 offset:9216
    s_add_u32 m0, s86, 0xc800
    s_nop 0
    buffer_load_dwordx4 v162, s[80:83], s84 offen lds
    s_add_u32 s84, s84, s85
    s_cmp_eq_u32 s84, s87
    s_cselect_b32 s84, 0, s84
    s_waitcnt lgkmcnt(7)
    s_cbranch_vccnz k1_xq19
    v_mfma_f32_16x16x32_bf16 v[84:87], v[68:71], v[44:47], v[84:87]
    s_branch k1_xr19
k1_xq19:
    v_mfma_f32_16x16x32_bf16 v[88:91], v[96:99], v[44:47], v[88:91]
k1_xr19:
    ds_read_b64_tr_b16 v[64:65], v16 offset:8192
    ds_read_b64_tr_b16 v[66:67], v16 offset:9216
    s_add_u32 m0, s94, 0xc800
    s_nop 0
    buffer_load_dwordx4 v163, s[88:91], s92 offen lds
    s_add_u32 s92, s92, s93
    s_cmp_eq_u32 s92, s95
    s_cselect_b32 s92, 0, s92
    s_waitcnt vmcnt(4)
    s_barrier
    s_waitcnt lgkmcnt(8)
    v_cndmask_b32 v48, v48, v96, s[38:39]
    v_cndmask_b32 v49, v49, v96, s[38:39]
    v_cndmask_b32 v50, v50, v96, s[38:39]
    v_cndmask_b32 v51, v51, v96, s[38:39]
    ds_read_b128 v[44:47], v40 offset:0
    s_nop 0
    s_waitcnt lgkmcnt(7)
    v_mfma_f32_16x16x32_bf16 v[72:75], v[52:55], v[48:51], v[72:75]
    ds_read_b64_tr_b16 v[68:69], v6 offset:0
    ds_read_b64_tr_b16 v[70:71], v6 offset:1024
    s_waitcnt lgkmcnt(7)
    v_mfma_f32_16x16x32_bf16 v[76:79], v[56:59], v[48:51], v[76:79]
    ds_read_b64_tr_b16 v[52:53], v7 offset:0
    ds_read_b64_tr_b16 v[54:55], v7 offset:1024
    s_waitcnt lgkmcnt(7)
    s_cbranch_vccnz k1_xq20
    v_mfma_f32_16x16x32_bf16 v[80:83], v[60:63], v[48:51], v[80:83]
    s_branch k1_xr20
k1_xq20:
    v_mfma_f32_16x16x32_bf16 v[92:95], v[48:51], v[48:51], v[92:95]
k1_xr20:
    ds_read_b64_tr_b16 v[56:57], v8 offset:0
    ds_read_b64_tr_b16 v[58:59], v8 offset:1024
    s_waitcnt lgkmcnt(7)
    s_cbranch_vccnz k1_xq21
    v_mfma_f32_16x16x32_bf16 v[84:87], v[64:67], v[48:51], v[84:87]
    s_branch k1_xr21
k1_xq21:
    v_mfma_f32_16x16x32_bf16 v[88:91], v[96:99], v[48:51], v[88:91]
k1_xr21:
    ds_read_b64_tr_b16 v[60:61], v9 offset:0
    ds_read_b64_tr_b16 v[62:63], v9 offset:1024
    s_barrier
    s_waitcnt lgkmcnt(8)
    v_cndmask_b32 v44, v44, v96, s[38:39]
    v_cndmask_b32 v45, v45, v96, s[38:39]
    v_cndmask_b32 v46, v46, v96, s[38:39]
    v_cndmask_b32 v47, v47, v96, s[38:39]
    ds_read_b128 v[48:51], v41 offset:0
    s_nop 0
    s_waitcnt lgkmcnt(7)
    v_mfma_f32_16x16x32_bf16 v[72:75], v[68:71], v[44:47], v[72:75]
    ds_read_b64_tr_b16 v[64:65], v6 offset:8192
    ds_read_b64_tr_b16 v[66:67], v6 offset:9216
    s_add_u32 m0, s70, 0x19000
    s_nop 0
    buffer_load_dwordx4 v160, s[64:67], s68 offen lds
    s_add_u32 s68, s68, s69
    s_cmp_eq_u32 s68, s71
    s_cselect_b32 s68, 0, s68
    s_waitcnt lgkmcnt(7)
    v_mfma_f32_16x16x32_bf16 v[76:79], v[52:55], v[44:47], v[76:79]
    ds_read_b64_tr_b16 v[68:69], v7 offset:8192
    ds_read_b64_tr_b16 v[70:71], v7 offset:9216
    s_add_u32 m0, s78, 0x19000
    s_nop 0
    buffer_load_dwordx4 v161, s[72:75], s76 offen lds
    s_add_u32 s76, s76, s77
    s_cmp_eq_u32 s76, s79
    s_cselect_b32 s76, 0, s76
    s_waitcnt lgkmcnt(7)
    s_cbranch_vccnz k1_xq22
    v_mfma_f32_16x16x32_bf16 v[80:83], v[56:59], v[44:47], v[80:83]
    s_branch k1_xr22
k1_xq22:
    v_mfma_f32_16x16x32_bf16 v[92:95], v[44:47], v[44:47], v[92:95]
k1_xr22:
    ds_read_b64_tr_b16 v[52:53], v8 offset:8192
    ds_read_b64_tr_b16 v[54:55], v8 offset:9216
    s_add_u32 m0, s86, 0x19000
    s_nop 0
    buffer_load_dwordx4 v162, s[80:83], s84 offen lds
    s_add_u32 s84, s84, s85
    s_cmp_eq_u32 s84, s87
    s_cselect_b32 s84, 0, s84
    s_waitcnt lgkmcnt(7)
    s_cbranch_vccnz k1_xq23
    v_mfma_f32_16x16x32_bf16 v[84:87], v[60:63], v[44:47], v[84:87]
    s_branch k1_xr23
k1_xq23:
    v_mfma_f32_16x16x32_bf16 v[88:91], v[96:99], v[44:47], v[88:91]
k1_xr23:
    ds_read_b64_tr_b16 v[56:57], v9 offset:8192
    ds_read_b64_tr_b16 v[58:59], v9 offset:9216
    s_add_u32 m0, s94, 0x19000
    s_nop 0
    buffer_load_dwordx4 v163, s[88:91], s92 offen lds
    s_add_u32 s92, s92, s93
    s_cmp_eq_u32 s92, s95
    s_cselect_b32 s92, 0, s92
    s_waitcnt vmcnt(4)
    s_barrier
    s_waitcnt lgkmcnt(8)
    v_cndmask_b32 v48, v48, v96, s[38:39]
    v_cndmask_b32 v49, v49, v96, s[38:39]
    v_cndmask_b32 v50, v50, v96, s[38:39]
    v_cndmask_b32 v51, v51, v96, s[38:39]
    ds_read_b128 v[44:47], v40 offset:51200
    s_nop 0
    s_waitcnt lgkmcnt(7)
    v_mfma_f32_16x16x32_bf16 v[72:75], v[64:67], v[48:51], v[72:75]
    ds_read_b64_tr_b16 v[60:61], v6 offset:51200
    ds_read_b64_tr_b16 v[62:63], v6 offset:52224
    s_waitcnt lgkmcnt(7)
    v_mfma_f32_16x16x32_bf16 v[76:79], v[68:71], v[48:51], v[76:79]
    ds_read_b64_tr_b16 v[64:65], v7 offset:51200
    ds_read_b64_tr_b16 v[66:67], v7 offset:52224
    s_waitcnt lgkmcnt(7)
    s_cbranch_vccnz k1_xq24
    v_mfma_f32_16x16x32_bf16 v[80:83], v[52:55], v[48:51], v[80:83]
    s_branch k1_xr24
k1_xq24:
    v_mfma_f32_16x16x32_bf16 v[92:95], v[48:51], v[48:51], v[92:95]
k1_xr24:
    ds_read_b64_tr_b16 v[68:69], v8 offset:51200
    ds_read_b64_tr_b16 v[70:71], v8 offset:52224
    s_waitcnt lgkmcnt(7)
    s_cbranch_vccnz k1_xq25
    v_mfma_f32_16x16x32_bf16 v[84:87], v[56:59], v[48:51], v[84:87]
    s_branch k1_xr25
k1_xq25:
    v_mfma_f32_16x16x32_bf16 v[88:91], v[96:99], v[48:51], v[88:91]
k1_xr25:
    ds_read_b64_tr_b16 v[52:53], v9 offset:51200
    ds_read_b64_tr_b16 v[54:55], v9 offset:52224
    s_barrier
    s_waitcnt lgkmcnt(8)
    v_cndmask_b32 v44, v44, v96, s[38:39]
    v_cndmask_b32 v45, v45, v96, s[38:39]
    v_cndmask_b32 v46, v46, v96, s[38:39]
    v_cndmask_b32 v47, v47, v96, s[38:39]
    ds_read_b128 v[48:51], v41 offset:51200
    s_nop 0
    s_waitcnt lgkmcnt(7)
    v_mfma_f32_16x16x32_bf16 v[72:75], v[60:63], v[44:47], v[72:75]
    ds_read_b64_tr_b16 v[56:57], v6 offset:59392
    ds_read_b64_tr_b16 v[58:59], v6 offset:60416
    s_add_u32 m0, s70, 0x0
    s_nop 0
    buffer_load_dwordx4 v160, s[64:67], s68 offen lds
    s_add_u32 s68, s68, s69
    s_cmp_eq_u32 s68, s71
    s_cselect_b32 s68, 0, s68
    s_waitcnt lgkmcnt(7)
    v_mfma_f32_16x16x32_bf16 v[76:79], v[64:67], v[44:47], v[76:79]
    ds_read_b64_tr_b16 v[60:61], v7 offset:59392
    ds_read_b64_tr_b16 v[62:63], v7 offset:60416
    s_add_u32 m0, s78, 0x0
    s_nop 0
    buffer_load_dwordx4 v161, s[72:75], s76 offen lds
    s_add_u32 s76, s76, s77
    s_cmp_eq_u32 s76, s79
    s_cselect_b32 s76, 0, s76
    s_waitcnt lgkmcnt(7)
    s_cbranch_vccnz k1_xq26
    v_mfma_f32_16x16x32_bf16 v[80:83], v[68:71], v[44:47], v[80:83]
    s_branch k1_xr26
k1_xq26:
    v_mfma_f32_16x16x32_bf16 v[92:95], v[44:47], v[44:47], v[92:95]
k1_xr26:
    ds_read_b64_tr_b16 v[64:65], v8 offset:59392
    ds_read_b64_tr_b16 v[66:67], v8 offset:60416
    s_add_u32 m0, s86, 0x0
    s_nop 0
    buffer_load_dwordx4 v162, s[80:83], s84 offen lds
    s_add_u32 s84, s84, s85
    s_cmp_eq_u32 s84, s87
    s_cselect_b32 s84, 0, s84
    s_waitcnt lgkmcnt(7)
    s_cbranch_vccnz k1_xq27
    v_mfma_f32_16x16x32_bf16 v[84:87], v[52:55], v[44:47], v[84:87]
    s_branch k1_xr27
k1_xq27:
    v_mfma_f32_16x16x32_bf16 v[88:91], v[96:99], v[44:47], v[88:91]
k1_xr27:
    ds_read_b64_tr_b16 v[68:69], v9 offset:59392
    ds_read_b64_tr_b16 v[70:71], v9 offset:60416
    s_add_u32 m0, s94, 0x0
    s_nop 0
    buffer_load_dwordx4 v163, s[88:91], s92 offen lds
    s_add_u32 s92, s92, s93
    s_cmp_eq_u32 s92, s95
    s_cselect_b32 s92, 0, s92
    s_waitcnt vmcnt(4)
    s_barrier
    s_waitcnt lgkmcnt(8)
    v_cndmask_b32 v48, v48, v96, s[38:39]
    v_cndmask_b32 v49, v49, v96, s[38:39]
    v_cndmask_b32 v50, v50, v96, s[38:39]
    v_cndmask_b32 v51, v51, v96, s[38:39]
    ds_read_b128 v[44:47], v42 offset:0
    s_nop 0
    s_waitcnt lgkmcnt(7)
    v_mfma_f32_16x16x32_bf16 v[72:75], v[56:59], v[48:51], v[72:75]
    ds_read_b64_tr_b16 v[52:53], v13 offset:0
    ds_read_b64_tr_b16 v[54:55], v13 offset:1024
    s_waitcnt lgkmcnt(7)
    v_mfma_f32_16x16x32_bf16 v[76:79], v[60:63], v[48:51], v[76:79]
    ds_read_b64_tr_b16 v[56:57], v14 offset:0
    ds_read_b64_tr_b16 v[58:59], v14 offset:1024
    s_waitcnt lgkmcnt(7)
    s_cbranch_vccnz k1_xq28
    v_mfma_f32_16x16x32_bf16 v[80:83], v[64:67], v[48:51], v[80:83]
    s_branch k1_xr28
k1_xq28:
    v_mfma_f32_16x16x32_bf16 v[92:95], v[48:51], v[48:51], v[92:95]
k1_xr28:
    ds_read_b64_tr_b16 v[60:61], v15 offset:0
    ds_read_b64_tr_b16 v[62:63], v15 offset:1024
    s_waitcnt lgkmcnt(7)
    s_cbranch_vccnz k1_xq29
    v_mfma_f32_16x16x32_bf16 v[84:87], v[68:71], v[48:51], v[84:87]
    s_branch k1_xr29
k1_xq29:
    v_mfma_f32_16x16x32_bf16 v[88:91], v[96:99], v[48:51], v[88:91]
k1_xr29:
    ds_read_b64_tr_b16 v[64:65], v16 offset:0
    ds_read_b64_tr_b16 v[66:67], v16 offset:1024
    s_barrier
    s_waitcnt lgkmcnt(8)
    v_cndmask_b32 v44, v44, v96, s[38:39]
    v_cndmask_b32 v45, v45, v96, s[38:39]
    v_cndmask_b32 v46, v46, v96, s[38:39]
    v_cndmask_b32 v47, v47, v96, s[38:39]
    ds_read_b128 v[48:51], v43 offset:0
    s_nop 0
    s_waitcnt lgkmcnt(7)
    v_mfma_f32_16x16x32_bf16 v[72:75], v[52:55], v[44:47], v[72:75]
    ds_read_b64_tr_b16 v[68:69], v13 offset:8192
    ds_read_b64_tr_b16 v[70:71], v13 offset:9216
    s_add_u32 m0, s70, 0xc800
    s_nop 0
    buffer_load_dwordx4 v160, s[64:67], s68 offen lds
    s_add_u32 s68, s68, s69
    s_cmp_eq_u32 s68, s71
    s_cselect_b32 s68, 0, s68
    s_waitcnt lgkmcnt(7)
    v_mfma_f32_16x16x32_bf16 v[76:79], v[56:59], v[44:47], v[76:79]
    ds_read_b64_tr_b16 v[52:53], v14 offset:8192
    ds_read_b64_tr_b16 v[54:55], v14 offset:9216
    s_add_u32 m0, s78, 0xc800
    s_nop 0
    buffer_load_dwordx4 v161, s[72:75], s76 offen lds
    s_add_u32 s76, s76, s77
    s_cmp_eq_u32 s76, s79
    s_cselect_b32 s76, 0, s76
    s_waitcnt lgkmcnt(7)
    s_cbranch_vccnz k1_xq30
    v_mfma_f32_16x16x32_bf16 v[80:83], v[60:63], v[44:47], v[80:83]
    s_branch k1_xr30
k1_xq30:
    v_mfma_f32_16x16x32_bf16 v[92:95], v[44:47], v[44:47], v[92:95]
k1_xr30:
    ds_read_b64_tr_b16 v[56:57], v15 offset:8192
    ds_read_b64_tr_b16 v[58:59], v15 offset:9216
    s_add_u32 m0, s86, 0xc800
    s_nop 0
    buffer_load_dwordx4 v162, s[80:83], s84 offen lds
    s_add_u32 s84, s84, s85
    s_cmp_eq_u32 s84, s87
    s_cselect_b32 s84, 0, s84
    s_waitcnt lgkmcnt(7)
    s_cbranch_vccnz k1_xq31
    v_mfma_f32_16x16x32_bf16 v[84:87], v[64:67], v[44:47], v[84:87]
    s_branch k1_xr31
k1_xq31:
    v_mfma_f32_16x16x32_bf16 v[88:91], v[96:99], v[44:47], v[88:91]
k1_xr31:
    ds_read_b64_tr_b16 v[60:61], v16 offset:8192
    ds_read_b64_tr_b16 v[62:63], v16 offset:9216
    s_add_u32 m0, s94, 0xc800
    s_nop 0
    buffer_load_dwordx4 v163, s[88:91], s92 offen lds
    s_add_u32 s92, s92, s93
    s_cmp_eq_u32 s92, s95
    s_cselect_b32 s92, 0, s92
    s_waitcnt vmcnt(4)
    s_barrier
    s_waitcnt lgkmcnt(8)
    v_cndmask_b32 v48, v48, v96, s[38:39]
    v_cndmask_b32 v49, v49, v96, s[38:39]
    v_cndmask_b32 v50, v50, v96, s[38:39]
    v_cndmask_b32 v51, v51, v96, s[38:39]
    ds_read_b128 v[44:47], v40 offset:0
    s_nop 0
    s_waitcnt lgkmcnt(7)
    v_mfma_f32_16x16x32_bf16 v[72:75], v[68:71], v[48:51], v[72:75]
    ds_read_b64_tr_b16 v[64:65], v6 offset:0
    ds_read_b64_tr_b16 v[66:67], v6 offset:1024
    s_waitcnt lgkmcnt(7)
    v_mfma_f32_16x16x32_bf16 v[76:79], v[52:55], v[48:51], v[76:79]
    ds_read_b64_tr_b16 v[68:69], v7 offset:0
    ds_read_b64_tr_b16 v[70:71], v7 offset:1024
    s_waitcnt lgkmcnt(7)
    s_cbranch_vccnz k1_xq32
    v_mfma_f32_16x16x32_bf16 v[80:83], v[56:59], v[48:51], v[80:83]
    s_branch k1_xr32
k1_xq32:
    v_mfma_f32_16x16x32_bf16 v[92:95], v[48:51], v[48:51], v[92:95]
k1_xr32:
    ds_read_b64_tr_b16 v[52:53], v8 offset:0
    ds_read_b64_tr_b16 v[54:55], v8 offset:1024
    s_waitcnt lgkmcnt(7)
    s_cbranch_vccnz k1_xq33
    v_mfma_f32_16x16x32_bf16 v[84:87], v[60:63], v[48:51], v[84:87]
    s_branch k1_xr33
k1_xq33:
    v_mfma_f32_16x16x32_bf16 v[88:91], v[96:99], v[48:51], v[88:91]
k1_xr33:
    ds_read_b64_tr_b16 v[56:57], v9 offset:0
    ds_read_b64_tr_b16 v[58:59], v9 offset:1024
    s_barrier
    s_waitcnt lgkmcnt(8)
    v_cndmask_b32 v44, v44, v96, s[38:39]
    v_cndmask_b32 v45, v45, v96, s[38:39]
    v_cndmask_b32 v46, v46, v96, s[38:39]
    v_cndmask_b32 v47, v47, v96, s[38:39]
    ds_read_b128 v[48:51], v41 offset:0
    s_nop 0
    s_waitcnt lgkmcnt(7)
    v_mfma_f32_16x16x32_bf16 v[72:75], v[64:67], v[44:47], v[72:75]
    ds_read_b64_tr_b16 v[60:61], v6 offset:8192
    ds_read_b64_tr_b16 v[62:63], v6 offset:9216
    s_add_u32 m0, s70, 0x19000
    s_nop 0
    buffer_load_dwordx4 v160, s[64:67], s68 offen lds
    s_add_u32 s68, s68, s69
    s_cmp_eq_u32 s68, s71
    s_cselect_b32 s68, 0, s68
    s_waitcnt lgkmcnt(7)
    v_mfma_f32_16x16x32_bf16 v[76:79], v[68:71], v[44:47], v[76:79]
    ds_read_b64_tr_b16 v[64:65], v7 offset:8192
    ds_read_b64_tr_b16 v[66:67], v7 offset:9216
    s_add_u32 m0, s78, 0x19000
    s_nop 0
    buffer_load_dwordx4 v161, s[72:75], s76 offen lds
    s_add_u32 s76, s76, s77
    s_cmp_eq_u32 s76, s79
    s_cselect_b32 s76, 0, s76
    s_waitcnt lgkmcnt(7)
    s_cbranch_vccnz k1_xq34
    v_mfma_f32_16x16x32_bf16 v[80:83], v[52:55], v[44:47], v[80:83]
    s_branch k1_xr34
k1_xq34:
    v_mfma_f32_16x16x32_bf16 v[92:95], v[44:47], v[44:47], v[92:95]
k1_xr34:
    ds_read_b64_tr_b16 v[68:69], v8 offset:8192
    ds_read_b64_tr_b16 v[70:71], v8 offset:9216
    s_add_u32 m0, s86, 0x19000
    s_nop 0
    buffer_load_dwordx4 v162, s[80:83], s84 offen lds
    s_add_u32 s84, s84, s85
    s_cmp_eq_u32 s84, s87
    s_cselect_b32 s84, 0, s84
    s_waitcnt lgkmcnt(7)
    s_cbranch_vccnz k1_xq35
    v_mfma_f32_16x16x32_bf16 v[84:87], v[56:59], v[44:47], v[84:87]
    s_branch k1_xr35
k1_xq35:
    v_mfma_f32_16x16x32_bf16 v[88:91], v[96:99], v[44:47], v[88:91]
k1_xr35:
    ds_read_b64_tr_b16 v[52:53], v9 offset:8192
    ds_read_b64_tr_b16 v[54:55], v9 offset:9216
    s_add_u32 m0, s94, 0x19000
    s_nop 0
    buffer_load_dwordx4 v163, s[88:91], s92 offen lds
    s_add_u32 s92, s92, s93
    s_cmp_eq_u32 s92, s95
    s_cselect_b32 s92, 0, s92
    s_waitcnt vmcnt(4)
    s_barrier
    s_waitcnt lgkmcnt(8)
    v_cndmask_b32 v48, v48, v96, s[38:39]
    v_cndmask_b32 v49, v49, v96, s[38:39]
    v_cndmask_b32 v50, v50, v96, s[38:39]
    v_cndmask_b32 v51, v51, v96, s[38:39]
    ds_read_b128 v[44:47], v40 offset:51200
    s_nop 0
    s_waitcnt lgkmcnt(7)
    v_mfma_f32_16x16x32_bf16 v[72:75], v[60:63], v[48:51], v[72:75]
    ds_read_b64_tr_b16 v[56:57], v6 offset:51200
    ds_read_b64_tr_b16 v[58:59], v6 offset:52224
    s_waitcnt lgkmcnt(7)
    v_mfma_f32_16x16x32_bf16 v[76:79], v[64:67], v[48:51], v[76:79]
    ds_read_b64_tr_b16 v[60:61], v7 offset:51200
    ds_read_b64_tr_b16 v[62:63], v7 offset:52224
    s_waitcnt lgkmcnt(7)
    s_cbranch_vccnz k1_xq36
    v_mfma_f32_16x16x32_bf16 v[80:83], v[68:71], v[48:51], v[80:83]
    s_branch k1_xr36
k1_xq36:
    v_mfma_f32_16x16x32_bf16 v[92:95], v[48:51], v[48:51], v[92:95]
k1_xr36:
    ds_read_b64_tr_b16 v[64:65], v8 offset:51200
    ds_read_b64_tr_b16 v[66:67], v8 offset:52224
    s_waitcnt lgkmcnt(7)
    s_cbranch_vccnz k1_xq37
    v_mfma_f32_16x16x32_bf16 v[84:87], v[52:55], v[48:51], v[84:87]
    s_branch k1_xr37
k1_xq37:
    v_mfma_f32_16x16x32_bf16 v[88:91], v[96:99], v[48:51], v[88:91]
k1_xr37:
    ds_read_b64_tr_b16 v[68:69], v9 offset:51200
    ds_read_b64_tr_b16 v[70:71], v9 offset:52224
    s_barrier
    s_lshr_b32 s54, s2, 1
    s_mov_b32 s46, 0xc8000
    s_cmp_lt_u32 s54, 20
    s_cselect_b64 s[56:57], s[60:61], s[62:63]
    s_cselect_b32 s58, s46, 0x1e0000
    s_cselect_b32 s47, 0, 640
    s_cselect_b64 s[36:37], -1, 0
    s_and_b32 s57, s57, 0xffff
    s_mov_b32 s59, 0x20000
    s_lshl_b32 s46, s54, 5
    s_sub_u32 s46, s46, s47
    s_movk_i32 s48, 1639
    s_lshl_b32 s49, s45, 3
    s_and_b32 s47, s2, 1
    s_mul_i32 s47, s47, 640
    v_add_u32 v35, 0, v1
    v_mul_lo_u32 v36, v35, s48
    v_lshrrev_b32 v36, 16, v36
    v_mul_u32_u24 v37, 40, v36
    v_sub_u32 v37, v35, v37
    v_add_u32 v36, s49, v36
    v_lshlrev_b32 v37, 4, v37
    v_add_u32 v5, s47, v37
    v_mul_u32_u24 v37, 1280, v36
    v_add_u32 v10, v37, v5
    v_add_u32 v36, s46, v36
    v_mul_lo_u32 v38, v36, s48
    v_lshrrev_b32 v38, 16, v38
    v_mul_u32_u24 v39, 40, v38
    v_sub_u32 v35, v36, v39
    v_lshrrev_b32 v37, 3, v35
    v_mul_u32_u24 v37, 10, v37
    v_and_b32 v38, 7, v35
    v_add3_u32 v37, v37, v38, v39
    v_subrev_u32 v38, 32, v35
    v_lshrrev_b32 v38, 1, v38
    v_mul_u32_u24 v38, 10, v38
    v_add3_u32 v38, v38, v39, 8
    v_and_b32 v39, 1, v35
    v_add_u32 v38, v38, v39
    v_cmp_gt_u32 s[34:35], 32, v35
    s_nop 1
    v_cndmask_b32 v37, v38, v37, s[34:35]
    v_cndmask_b32 v36, v36, v37, s[36:37]
    v_mul_u32_u24 v36, 1280, v36
    v_add_u32 v36, v36, v5
    buffer_load_dwordx4 v[100:103], v36, s[56:59], 0 offen
    v_add_u32 v35, 64, v1
    v_mul_lo_u32 v36, v35, s48
    v_lshrrev_b32 v36, 16, v36
    v_mul_u32_u24 v37, 40, v36
    v_sub_u32 v37, v35, v37
    v_add_u32 v36, s49, v36
    v_lshlrev_b32 v37, 4, v37
    v_add_u32 v5, s47, v37
    v_mul_u32_u24 v37, 1280, v36
    v_add_u32 v11, v37, v5
    v_add_u32 v36, s46, v36
    v_mul_lo_u32 v38, v36, s48
    v_lshrrev_b32 v38, 16, v38
    v_mul_u32_u24 v39, 40, v38
    v_sub_u32 v35, v36, v39
    v_lshrrev_b32 v37, 3, v35
    v_mul_u32_u24 v37, 10, v37
    v_and_b32 v38, 7, v35
    v_add3_u32 v37, v37, v38, v39
    v_subrev_u32 v38, 32, v35
    v_lshrrev_b32 v38, 1, v38
    v_mul_u32_u24 v38, 10, v38
    v_add3_u32 v38, v38, v39, 8
    v_and_b32 v39, 1, v35
    v_add_u32 v38, v38, v39
    v_cmp_gt_u32 s[34:35], 32, v35
    s_nop 1
    v_cndmask_b32 v37, v38, v37, s[34:35]
    v_cndmask_b32 v36, v36, v37, s[36:37]
    v_mul_u32_u24 v36, 1280, v36
    v_add_u32 v36, v36, v5
    buffer_load_dwordx4 v[104:107], v36, s[56:59], 0 offen
    v_add_u32 v35, 128, v1
    v_mul_lo_u32 v36, v35, s48
    v_lshrrev_b32 v36, 16, v36
    v_mul_u32_u24 v37, 40, v36
    v_sub_u32 v37, v35, v37
    v_add_u32 v36, s49, v36
    v_lshlrev_b32 v37, 4, v37
    v_add_u32 v5, s47, v37
    v_mul_u32_u24 v37, 1280, v36
    v_add_u32 v12, v37, v5
    v_add_u32 v36, s46, v36
    v_mul_lo_u32 v38, v36, s48
    v_lshrrev_b32 v38, 16, v38
    v_mul_u32_u24 v39, 40, v38
    v_sub_u32 v35, v36, v39
    v_lshrrev_b32 v37, 3, v35
    v_mul_u32_u24 v37, 10, v37
    v_and_b32 v38, 7, v35
    v_add3_u32 v37, v37, v38, v39
    v_subrev_u32 v38, 32, v35
    v_lshrrev_b32 v38, 1, v38
    v_mul_u32_u24 v38, 10, v38
    v_add3_u32 v38, v38, v39, 8
    v_and_b32 v39, 1, v35
    v_add_u32 v38, v38, v39
    v_cmp_gt_u32 s[34:35], 32, v35
    s_nop 1
    v_cndmask_b32 v37, v38, v37, s[34:35]
    v_cndmask_b32 v36, v36, v37, s[36:37]
    v_mul_u32_u24 v36, 1280, v36
    v_add_u32 v36, v36, v5
    buffer_load_dwordx4 v[108:111], v36, s[56:59], 0 offen
    v_add_u32 v35, 192, v1
    v_mul_lo_u32 v36, v35, s48
    v_lshrrev_b32 v36, 16, v36
    v_mul_u32_u24 v37, 40, v36
    v_sub_u32 v37, v35, v37
    v_add_u32 v36, s49, v36
    v_lshlrev_b32 v37, 4, v37
    v_add_u32 v5, s47, v37
    v_mul_u32_u24 v37, 1280, v36
    v_add_u32 v17, v37, v5
    v_add_u32 v36, s46, v36
    v_mul_lo_u32 v38, v36, s48
    v_lshrrev_b32 v38, 16, v38
    v_mul_u32_u24 v39, 40, v38
    v_sub_u32 v35, v36, v39
    v_lshrrev_b32 v37, 3, v35
    v_mul_u32_u24 v37, 10, v37
    v_and_b32 v38, 7, v35
    v_add3_u32 v37, v37, v38, v39
    v_subrev_u32 v38, 32, v35
    v_lshrrev_b32 v38, 1, v38
    v_mul_u32_u24 v38, 10, v38
    v_add3_u32 v38, v38, v39, 8
    v_and_b32 v39, 1, v35
    v_add_u32 v38, v38, v39
    v_cmp_gt_u32 s[34:35], 32, v35
    s_nop 1
    v_cndmask_b32 v37, v38, v37, s[34:35]
    v_cndmask_b32 v36, v36, v37, s[36:37]
    v_mul_u32_u24 v36, 1280, v36
    v_add_u32 v36, v36, v5
    buffer_load_dwordx4 v[112:115], v36, s[56:59], 0 offen
    v_add_u32 v35, 256, v1
    v_mul_lo_u32 v36, v35, s48
    v_lshrrev_b32 v36, 16, v36
    v_mul_u32_u24 v37, 40, v36
    v_sub_u32 v37, v35, v37
    v_add_u32 v36, s49, v36
    v_lshlrev_b32 v37, 4, v37
    v_add_u32 v5, s47, v37
    v_mul_u32_u24 v37, 1280, v36
    v_add_u32 v18, v37, v5
    v_add_u32 v36, s46, v36
    v_mul_lo_u32 v38, v36, s48
    v_lshrrev_b32 v38, 16, v38
    v_mul_u32_u24 v39, 40, v38
    v_sub_u32 v35, v36, v39
    v_lshrrev_b32 v37, 3, v35
    v_mul_u32_u24 v37, 10, v37
    v_and_b32 v38, 7, v35
    v_add3_u32 v37, v37, v38, v39
    v_subrev_u32 v38, 32, v35
    v_lshrrev_b32 v38, 1, v38
    v_mul_u32_u24 v38, 10, v38
    v_add3_u32 v38, v38, v39, 8
    v_and_b32 v39, 1, v35
    v_add_u32 v38, v38, v39
    v_cmp_gt_u32 s[34:35], 32, v35
    s_nop 1
    v_cndmask_b32 v37, v38, v37, s[34:35]
    v_cndmask_b32 v36, v36, v37, s[36:37]
    v_mul_u32_u24 v36, 1280, v36
    v_add_u32 v36, v36, v5
    buffer_load_dwordx4 v[116:119], v36, s[56:59], 0 offen
    s_waitcnt lgkmcnt(8)
    v_cndmask_b32 v44, v44, v96, s[38:39]
    v_cndmask_b32 v45, v45, v96, s[38:39]
    v_cndmask_b32 v46, v46, v96, s[38:39]
    v_cndmask_b32 v47, v47, v96, s[38:39]
    ds_read_b128 v[48:51], v41 offset:51200
    s_nop 0
    s_waitcnt lgkmcnt(7)
    v_mfma_f32_16x16x32_bf16 v[72:75], v[56:59], v[44:47], v[72:75]
    ds_read_b64_tr_b16 v[52:53], v6 offset:59392
    ds_read_b64_tr_b16 v[54:55], v6 offset:60416
    s_add_u32 m0, s70, 0x0
    s_nop 0
    buffer_load_dwordx4 v160, s[64:67], s68 offen lds
    s_add_u32 s68, s68, s69
    s_cmp_eq_u32 s68, s71
    s_cselect_b32 s68, 0, s68
    s_waitcnt lgkmcnt(7)
    v_mfma_f32_16x16x32_bf16 v[76:79], v[60:63], v[44:47], v[76:79]
    ds_read_b64_tr_b16 v[56:57], v7 offset:59392
    ds_read_b64_tr_b16 v[58:59], v7 offset:60416
    s_add_u32 m0, s78, 0x0
    s_nop 0
    buffer_load_dwordx4 v161, s[72:75], s76 offen lds
    s_add_u32 s76, s76, s77
    s_cmp_eq_u32 s76, s79
    s_cselect_b32 s76, 0, s76
    s_waitcnt lgkmcnt(7)
    s_cbranch_vccnz k1_xq38
    v_mfma_f32_16x16x32_bf16 v[80:83], v[64:67], v[44:47], v[80:83]
    s_branch k1_xr38
k1_xq38:
    v_mfma_f32_16x16x32_bf16 v[92:95], v[44:47], v[44:47], v[92:95]
k1_xr38:
    ds_read_b64_tr_b16 v[60:61], v8 offset:59392
    ds_read_b64_tr_b16 v[62:63], v8 offset:60416
    s_add_u32 m0, s86, 0x0
    s_nop 0
    buffer_load_dwordx4 v162, s[80:83], s84 offen lds
    s_add_u32 s84, s84, s85
    s_cmp_eq_u32 s84, s87
    s_cselect_b32 s84, 0, s84
    s_waitcnt lgkmcnt(7)
    s_cbranch_vccnz k1_xq39
    v_mfma_f32_16x16x32_bf16 v[84:87], v[68:71], v[44:47], v[84:87]
    s_branch k1_xr39
k1_xq39:
    v_mfma_f32_16x16x32_bf16 v[88:91], v[96:99], v[44:47], v[88:91]
k1_xr39:
    ds_read_b64_tr_b16 v[64:65], v9 offset:59392
    ds_read_b64_tr_b16 v[66:67], v9 offset:60416
    s_add_u32 m0, s94, 0x0
    s_nop 0
    buffer_load_dwordx4 v163, s[88:91], s92 offen lds
    s_add_u32 s92, s92, s93
    s_cmp_eq_u32 s92, s95
    s_cselect_b32 s92, 0, s92
    s_waitcnt vmcnt(9)
    s_barrier
    s_waitcnt lgkmcnt(8)
    v_cndmask_b32 v48, v48, v96, s[38:39]
    v_cndmask_b32 v49, v49, v96, s[38:39]
    v_cndmask_b32 v50, v50, v96, s[38:39]
    v_cndmask_b32 v51, v51, v96, s[38:39]
    ds_read_b128 v[44:47], v42 offset:0
    s_nop 0
    s_waitcnt lgkmcnt(7)
    v_mfma_f32_16x16x32_bf16 v[72:75], v[52:55], v[48:51], v[72:75]
    ds_read_b64_tr_b16 v[68:69], v13 offset:0
    ds_read_b64_tr_b16 v[70:71], v13 offset:1024
    s_waitcnt lgkmcnt(7)
    v_mfma_f32_16x16x32_bf16 v[76:79], v[56:59], v[48:51], v[76:79]
    ds_read_b64_tr_b16 v[52:53], v14 offset:0
    ds_read_b64_tr_b16 v[54:55], v14 offset:1024
    s_waitcnt lgkmcnt(7)
    s_cbranch_vccnz k1_xq40
    v_mfma_f32_16x16x32_bf16 v[80:83], v[60:63], v[48:51], v[80:83]
    s_branch k1_xr40
k1_xq40:
    v_mfma_f32_16x16x32_bf16 v[92:95], v[48:51], v[48:51], v[92:95]
k1_xr40:
    ds_read_b64_tr_b16 v[56:57], v15 offset:0
    ds_read_b64_tr_b16 v[58:59], v15 offset:1024
    s_waitcnt lgkmcnt(7)
    s_cbranch_vccnz k1_xq41
    v_mfma_f32_16x16x32_bf16 v[84:87], v[64:67], v[48:51], v[84:87]
    s_branch k1_xr41
k1_xq41:
    v_mfma_f32_16x16x32_bf16 v[88:91], v[96:99], v[48:51], v[88:91]
k1_xr41:
    ds_read_b64_tr_b16 v[60:61], v16 offset:0
    ds_read_b64_tr_b16 v[62:63], v16 offset:1024
    s_barrier
    s_waitcnt lgkmcnt(8)
    v_cndmask_b32 v44, v44, v96, s[38:39]
    v_cndmask_b32 v45, v45, v96, s[38:39]
    v_cndmask_b32 v46, v46, v96, s[38:39]
    v_cndmask_b32 v47, v47, v96, s[38:39]
    ds_read_b128 v[48:51], v43 offset:0
    s_nop 0
    s_waitcnt lgkmcnt(7)
    v_mfma_f32_16x16x32_bf16 v[72:75], v[68:71], v[44:47], v[72:75]
    ds_read_b64_tr_b16 v[64:65], v13 offset:8192
    ds_read_b64_tr_b16 v[66:67], v13 offset:9216
    s_waitcnt lgkmcnt(7)
    v_mfma_f32_16x16x32_bf16 v[76:79], v[52:55], v[44:47], v[76:79]
    ds_read_b64_tr_b16 v[68:69], v14 offset:8192
    ds_read_b64_tr_b16 v[70:71], v14 offset:9216
    s_waitcnt lgkmcnt(7)
    s_cbranch_vccnz k1_xq42
    v_mfma_f32_16x16x32_bf16 v[80:83], v[56:59], v[44:47], v[80:83]
    s_branch k1_xr42
k1_xq42:
    v_mfma_f32_16x16x32_bf16 v[92:95], v[44:47], v[44:47], v[92:95]
k1_xr42:
    ds_read_b64_tr_b16 v[52:53], v15 offset:8192
    ds_read_b64_tr_b16 v[54:55], v15 offset:9216
    s_waitcnt lgkmcnt(7)
    s_cbranch_vccnz k1_xq43
    v_mfma_f32_16x16x32_bf16 v[84:87], v[60:63], v[44:47], v[84:87]
    s_branch k1_xr43
k1_xq43:
    v_mfma_f32_16x16x32_bf16 v[88:91], v[96:99], v[44:47], v[88:91]
k1_xr43:
    ds_read_b64_tr_b16 v[56:57], v16 offset:8192
    ds_read_b64_tr_b16 v[58:59], v16 offset:9216
    s_waitcnt vmcnt(0)
    s_barrier
    s_waitcnt lgkmcnt(8)
    v_cndmask_b32 v48, v48, v96, s[38:39]
    v_cndmask_b32 v49, v49, v96, s[38:39]
    v_cndmask_b32 v50, v50, v96, s[38:39]
    v_cndmask_b32 v51, v51, v96, s[38:39]
    ds_read_b128 v[44:47], v40 offset:0
    s_nop 0
    s_waitcnt lgkmcnt(7)
    v_mfma_f32_16x16x32_bf16 v[72:75], v[64:67], v[48:51], v[72:75]
    ds_read_b64_tr_b16 v[60:61], v6 offset:0
    ds_read_b64_tr_b16 v[62:63], v6 offset:1024
    s_waitcnt lgkmcnt(7)
    v_mfma_f32_16x16x32_bf16 v[76:79], v[68:71], v[48:51], v[76:79]
    ds_read_b64_tr_b16 v[64:65], v7 offset:0
    ds_read_b64_tr_b16 v[66:67], v7 offset:1024
    s_waitcnt lgkmcnt(7)
    s_cbranch_vccnz k1_xq44
    v_mfma_f32_16x16x32_bf16 v[80:83], v[52:55], v[48:51], v[80:83]
    s_branch k1_xr44
k1_xq44:
    v_mfma_f32_16x16x32_bf16 v[92:95], v[48:51], v[48:51], v[92:95]
k1_xr44:
    ds_read_b64_tr_b16 v[68:69], v8 offset:0
    ds_read_b64_tr_b16 v[70:71], v8 offset:1024
    s_waitcnt lgkmcnt(7)
    s_cbranch_vccnz k1_xq45
    v_mfma_f32_16x16x32_bf16 v[84:87], v[56:59], v[48:51], v[84:87]
    s_branch k1_xr45
k1_xq45:
    v_mfma_f32_16x16x32_bf16 v[88:91], v[96:99], v[48:51], v[88:91]
k1_xr45:
    ds_read_b64_tr_b16 v[52:53], v9 offset:0
    ds_read_b64_tr_b16 v[54:55], v9 offset:1024
    s_barrier
    s_waitcnt lgkmcnt(8)
    v_cndmask_b32 v44, v44, v96, s[38:39]
    v_cndmask_b32 v45, v45, v96, s[38:39]
    v_cndmask_b32 v46, v46, v96, s[38:39]
    v_cndmask_b32 v47, v47, v96, s[38:39]
    ds_read_b128 v[48:51], v41 offset:0
    s_nop 0
    s_waitcnt lgkmcnt(7)
    v_mfma_f32_16x16x32_bf16 v[72:75], v[60:63], v[44:47], v[72:75]
    ds_read_b64_tr_b16 v[56:57], v6 offset:8192
    ds_read_b64_tr_b16 v[58:59], v6 offset:9216
    s_waitcnt lgkmcnt(7)
    v_mfma_f32_16x16x32_bf16 v[76:79], v[64:67], v[44:47], v[76:79]
    ds_read_b64_tr_b16 v[60:61], v7 offset:8192
    ds_read_b64_tr_b16 v[62:63], v7 offset:9216
    s_waitcnt lgkmcnt(7)
    s_cbranch_vccnz k1_xq46
    v_mfma_f32_16x16x32_bf16 v[80:83], v[68:71], v[44:47], v[80:83]
    s_branch k1_xr46
k1_xq46:
    v_mfma_f32_16x16x32_bf16 v[92:95], v[44:47], v[44:47], v[92:95]
k1_xr46:
    ds_read_b64_tr_b16 v[64:65], v8 offset:8192
    ds_read_b64_tr_b16 v[66:67], v8 offset:9216
    s_waitcnt lgkmcnt(7)
    s_cbranch_vccnz k1_xq47
    v_mfma_f32_16x16x32_bf16 v[84:87], v[52:55], v[44:47], v[84:87]
    s_branch k1_xr47
k1_xq47:
    v_mfma_f32_16x16x32_bf16 v[88:91], v[96:99], v[44:47], v[88:91]
k1_xr47:
    ds_read_b64_tr_b16 v[68:69], v9 offset:8192
    ds_read_b64_tr_b16 v[70:71], v9 offset:9216
    s_waitcnt lgkmcnt(8)
    v_cndmask_b32 v48, v48, v96, s[38:39]
    v_cndmask_b32 v49, v49, v96, s[38:39]
    v_cndmask_b32 v50, v50, v96, s[38:39]
    v_cndmask_b32 v51, v51, v96, s[38:39]
    s_nop 0
    s_waitcnt lgkmcnt(6)
    v_mfma_f32_16x16x32_bf16 v[72:75], v[56:59], v[48:51], v[72:75]
    s_waitcnt lgkmcnt(4)
    v_mfma_f32_16x16x32_bf16 v[76:79], v[60:63], v[48:51], v[76:79]
    s_waitcnt lgkmcnt(2)
    s_cbranch_vccnz k1_xq48
    v_mfma_f32_16x16x32_bf16 v[80:83], v[64:67], v[48:51], v[80:83]
    s_branch k1_xr48
k1_xq48:
    v_mfma_f32_16x16x32_bf16 v[92:95], v[48:51], v[48:51], v[92:95]
k1_xr48:
    s_waitcnt lgkmcnt(0)
    s_cbranch_vccnz k1_xq49
    v_mfma_f32_16x16x32_bf16 v[84:87], v[68:71], v[48:51], v[84:87]
    s_branch k1_xr49
k1_xq49:
    v_mfma_f32_16x16x32_bf16 v[88:91], v[96:99], v[48:51], v[88:91]
k1_xr49:
    s_nop 7
    s_nop 3
    v_lshlrev_b32 v45, 4, v2
    v_add_u32 v45, 0x25800, v45
    s_cmp_lg_u32 s45, 3
    s_cbranch_scc1 k1_x_nostat
    v_and_b32 v36, 3, v2
    v_mov_b32 v37, v92
    v_cmp_eq_u32 vcc, 1, v36
    s_nop 1
    v_cndmask_b32 v37, v37, v93, vcc
    v_cmp_eq_u32 vcc, 2, v36
    s_nop 1
    v_cndmask_b32 v37, v37, v94, vcc
    v_cmp_eq_u32 vcc, 3, v36
    s_nop 1
    v_cndmask_b32 v37, v37, v95, vcc
    v_lshrrev_b32 v36, 2, v2
    v_lshl_add_u32 v36, v36, 4, v2
    v_lshlrev_b32 v36, 2, v36
    ds_bpermute_b32 v38, v36, v37
    s_waitcnt lgkmcnt(0)
    v_mul_f32 v36, 0x3acccccd, v88
    v_mul_f32 v38, 0x3acccccd, v38
    v_fma_f32 v38, -v36, v36, v38
    v_max_f32 v38, 0, v38
    v_mov_b32 v39, v36
    v_cvt_pk_bf16_f32 v39, v39, v39
    v_lshlrev_b32 v39, 16, v39
    v_mov_b32 v37, v38
    v_cvt_pk_bf16_f32 v37, v37, v37
    v_lshlrev_b32 v37, 16, v37
    v_add_f32 v37, 0x3727c5ac, v37
    v_cvt_pk_bf16_f32 v37, v37, v37
    v_lshlrev_b32 v37, 16, v37
    v_sqrt_f32 v37, v37
    s_nop 0
    v_cvt_pk_bf16_f32 v37, v37, v37
    v_lshlrev_b32 v37, 16, v37
    v_rcp_f32 v40, v37
    v_sub_f32 v36, v36, v39
    v_mul_f32 v36, v36, v40
    v_cvt_pk_bf16_f32 v36, v36, v36
    v_lshlrev_b32 v36, 16, v36
    v_mul_f32 v37, v40, v40
    v_mul_f32 v37, v37, v38
    v_cvt_pk_bf16_f32 v37, v37, v37
    v_lshlrev_b32 v37, 16, v37
    v_add_f32 v37, 0x3727c5ac, v37
    v_cvt_pk_bf16_f32 v37, v37, v37
    v_lshlrev_b32 v37, 16, v37
    v_sqrt_f32 v37, v37
    s_nop 0
    v_cvt_pk_bf16_f32 v37, v37, v37
    v_lshlrev_b32 v37, 16, v37
    v_rcp_f32 v37, v37
    v_mul_f32 v41, v40, v39
    v_add_f32 v36, v36, v41
    v_mul_f32 v42, v40, v37
    v_mul_f32 v43, v36, v37
    ds_write_b128 v45, v[40:43]
k1_x_nostat:
    s_lshl_b32 s46, s45, 8
    s_add_u32 s46, s46, 0x26100
    v_lshl_add_u32 v36, v3, 4, s46
    s_mov_b64 s[36:37], exec
    s_mov_b64 exec, s[38:39]
    ds_write_b128 v36, v[72:75] offset:0
    ds_write_b128 v36, v[76:79] offset:64
    s_cmp_eq_u32 s45, 3
    s_cbranch_scc1 k1_x_skipcs
    ds_write_b128 v36, v[80:83] offset:128
    ds_write_b128 v36, v[84:87] offset:192
k1_x_skipcs:
    s_mov_b64 exec, s[36:37]
    s_waitcnt lgkmcnt(0)
    s_barrier
    s_movk_i32 s48, 1639
    s_lshl_b32 s49, s45, 3
    v_mov_b32 v44, v36
    v_add_u32 v35, 0, v1
    v_mul_lo_u32 v36, v35, s48
    v_lshrrev_b32 v36, 16, v36
    v_mul_u32_u24 v37, 40, v36
    v_sub_u32 v37, v35, v37
    v_add_u32 v36, s49, v36
    v_lshrrev_b32 v39, 1, v36
    v_and_b32 v39, 4, v39
    v_xor_b32 v38, v36, v39
    v_mul_u32_u24 v38, 672, v38
    v_lshl_add_u32 v38, v37, 4, v38
    v_add_u32 v38, 0xc000, v38
    ds_write_b128 v38, v[100:103]
    v_add_u32 v35, 64, v1
    v_mul_lo_u32 v36, v35, s48
    v_lshrrev_b32 v36, 16, v36
    v_mul_u32_u24 v37, 40, v36
    v_sub_u32 v37, v35, v37
    v_add_u32 v36, s49, v36
    v_lshrrev_b32 v39, 1, v36
    v_and_b32 v39, 4, v39
    v_xor_b32 v38, v36, v39
    v_mul_u32_u24 v38, 672, v38
    v_lshl_add_u32 v38, v37, 4, v38
    v_add_u32 v38, 0xc000, v38
    ds_write_b128 v38, v[104:107]
    v_add_u32 v35, 128, v1
    v_mul_lo_u32 v36, v35, s48
    v_lshrrev_b32 v36, 16, v36
    v_mul_u32_u24 v37, 40, v36
    v_sub_u32 v37, v35, v37
    v_add_u32 v36, s49, v36
    v_lshrrev_b32 v39, 1, v36
    v_and_b32 v39, 4, v39
    v_xor_b32 v38, v36, v39
    v_mul_u32_u24 v38, 672, v38
    v_lshl_add_u32 v38, v37, 4, v38
    v_add_u32 v38, 0xc000, v38
    ds_write_b128 v38, v[108:111]
    v_add_u32 v35, 192, v1
    v_mul_lo_u32 v36, v35, s48
    v_lshrrev_b32 v36, 16, v36
    v_mul_u32_u24 v37, 40, v36
    v_sub_u32 v37, v35, v37
    v_add_u32 v36, s49, v36
    v_lshrrev_b32 v39, 1, v36
    v_and_b32 v39, 4, v39
    v_xor_b32 v38, v36, v39
    v_mul_u32_u24 v38, 672, v38
    v_lshl_add_u32 v38, v37, 4, v38
    v_add_u32 v38, 0xc000, v38
    ds_write_b128 v38, v[112:115]
    v_add_u32 v35, 256, v1
    v_mul_lo_u32 v36, v35, s48
    v_lshrrev_b32 v36, 16, v36
    v_mul_u32_u24 v37, 40, v36
    v_sub_u32 v37, v35, v37
    v_add_u32 v36, s49, v36
    v_lshrrev_b32 v39, 1, v36
    v_and_b32 v39, 4, v39
    v_xor_b32 v38, v36, v39
    v_mul_u32_u24 v38, 672, v38
    v_lshl_add_u32 v38, v37, 4, v38
    v_add_u32 v38, 0xc000, v38
    ds_write_b128 v38, v[116:119]
    v_mov_b32 v36, v44
    s_cmp_ge_u32 s45, 2
    s_cbranch_scc1 k1_x_done
    ds_read_b128 v[40:43], v45
    ds_read_b128 v[48:51], v36 offset:0
    ds_read_b128 v[52:55], v36 offset:64
    ds_read_b128 v[56:59], v36 offset:128
    ds_read_b128 v[60:63], v36 offset:192
    s_waitcnt lgkmcnt(0)
    s_lshl_b32 s46, s45, 4
    s_add_u32 s46, s46, 0
    v_mul_f32 v64, v41, v48
    v_fma_f32 v72, v72, v40, -v64
    v_mul_f32 v64, v41, v49
    v_fma_f32 v73, v73, v40, -v64
    v_mul_f32 v64, v41, v50
    v_fma_f32 v74, v74, v40, -v64
    v_mul_f32 v64, v41, v51
    v_fma_f32 v75, v75, v40, -v64
    v_cvt_pk_bf16_f32 v72, v72, v73
    v_cvt_pk_bf16_f32 v73, v74, v75
    v_add_u32 v64, s46, v3
    v_mul_u32_u24 v65, 52, v64
    v_lshrrev_b32 v65, 8, v65
    v_add_u32 v64, v64, v65
    v_mul_u32_u24 v66, 304, v2
    v_lshl_add_u32 v66, v64, 3, v66
    ds_write_b64 v66, v[72:73]
    s_cmp_eq_u32 s45, 1
    s_cbranch_scc1 k1_x_done
    s_lshl_b32 s46, s45, 4
    s_add_u32 s46, s46, 4
    v_mul_f32 v64, v41, v52
    v_fma_f32 v76, v76, v40, -v64
    v_mul_f32 v64, v41, v53
    v_fma_f32 v77, v77, v40, -v64
    v_mul_f32 v64, v41, v54
    v_fma_f32 v78, v78, v40, -v64
    v_mul_f32 v64, v41, v55
    v_fma_f32 v79, v79, v40, -v64
    v_cvt_pk_bf16_f32 v76, v76, v77
    v_cvt_pk_bf16_f32 v77, v78, v79
    v_add_u32 v64, s46, v3
    v_mul_u32_u24 v65, 52, v64
    v_lshrrev_b32 v65, 8, v65
    v_add_u32 v64, v64, v65
    v_mul_u32_u24 v66, 304, v2
    v_lshl_add_u32 v66, v64, 3, v66
    ds_write_b64 v66, v[76:77]
    s_lshl_b32 s46, s45, 4
    s_add_u32 s46, s46, 8
    v_mul_f32 v64, v41, v56
    v_fma_f32 v80, v80, v40, -v64
    v_mul_f32 v64, v41, v57
    v_fma_f32 v81, v81, v40, -v64
    v_mul_f32 v64, v41, v58
    v_fma_f32 v82, v82, v40, -v64
    v_mul_f32 v64, v41, v59
    v_fma_f32 v83, v83, v40, -v64
    v_cvt_pk_bf16_f32 v80, v80, v81
    v_cvt_pk_bf16_f32 v81, v82, v83
    v_add_u32 v64, s46, v3
    v_mul_u32_u24 v65, 52, v64
    v_lshrrev_b32 v65, 8, v65
    v_add_u32 v64, v64, v65
    v_mul_u32_u24 v66, 304, v2
    v_lshl_add_u32 v66, v64, 3, v66
    ds_write_b64 v66, v[80:81]
    s_lshl_b32 s46, s45, 4
    s_add_u32 s46, s46, 12
    v_mul_f32 v64, v41, v60
    v_fma_f32 v84, v84, v40, -v64
    v_mul_f32 v64, v41, v61
    v_fma_f32 v85, v85, v40, -v64
    v_mul_f32 v64, v41, v62
    v_fma_f32 v86, v86, v40, -v64
    v_mul_f32 v64, v41, v63
    v_fma_f32 v87, v87, v40, -v64
    v_cvt_pk_bf16_f32 v84, v84, v85
    v_cvt_pk_bf16_f32 v85, v86, v87
    v_add_u32 v64, s46, v3
    v_mul_u32_u24 v65, 52, v64
    v_lshrrev_b32 v65, 8, v65
    v_add_u32 v64, v64, v65
    v_mul_u32_u24 v66, 304, v2
    v_lshl_add_u32 v66, v64, 3, v66
    ds_write_b64 v66, v[84:85]
k1_x_done:
    s_waitcnt lgkmcnt(0)
    s_barrier
    v_and_b32 v36, 1, v3
    v_lshl_add_u32 v37, v3, 3, v30
    v_lshl_add_u32 v37, v36, 2, v37
    v_xor_b32 v38, 4, v37
    v_mul_u32_u24 v37, 672, v37
    v_mul_u32_u24 v38, 672, v38
    v_lshl_add_u32 v37, v31, 3, v37
    v_lshl_add_u32 v38, v31, 3, v38
    s_mul_i32 s46, s45, 160
    s_add_u32 s46, s46, 0xc000
    v_add_u32 v37, s46, v37
    v_add_u32 v38, s46, v38
    s_and_b32 s47, s2, 1
    s_lshl_b32 s47, s47, 2
    s_add_u32 s47, s47, s45
    s_mul_i32 s47, s47, 68
    s_lshr_b32 s48, s2, 1
    s_add_u32 s47, s47, s48
    s_mul_i32 s47, s47, 5120
    s_add_u32 s46, s47, 0x880000
    v_lshl_add_u32 v39, v1, 4, s46
    v_add_u32 v40, 0x1000, v39
    s_cmp_ge_u32 s2, 136
    s_cbranch_scc1 k1_end
    ds_read_b64_tr_b16 v[100:101], v37 offset:0
    ds_read_b64_tr_b16 v[102:103], v38 offset:0
    ds_read_b64_tr_b16 v[104:105], v37 offset:32
    ds_read_b64_tr_b16 v[106:107], v38 offset:32
    ds_read_b64_tr_b16 v[108:109], v37 offset:64
    ds_read_b64_tr_b16 v[110:111], v38 offset:64
    ds_read_b64_tr_b16 v[112:113], v37 offset:96
    ds_read_b64_tr_b16 v[114:115], v38 offset:96
    ds_read_b64_tr_b16 v[116:117], v37 offset:128
    ds_read_b64_tr_b16 v[118:119], v38 offset:128
    s_mov_b32 s47, 0x0
    s_waitcnt lgkmcnt(0)
    buffer_store_dwordx4 v[100:103], v39, s[24:27], s47 offen offset:0 sc1
    buffer_store_dwordx4 v[104:107], v39, s[24:27], s47 offen offset:1024 sc1
    buffer_store_dwordx4 v[108:111], v39, s[24:27], s47 offen offset:2048 sc1
    buffer_store_dwordx4 v[112:115], v39, s[24:27], s47 offen offset:3072 sc1
    buffer_store_dwordx4 v[116:119], v40, s[24:27], s47 offen sc1
k1_end:
    s_endpgm
.globl k2_kernel
.p2align 8
.type k2_kernel,@function
k2_kernel:
    s_cmp_ge_u32 s2, 256
    s_cbranch_scc1 k2_end
    s_load_dwordx2 s[36:37], s[0:1], 0
    s_load_dwordx4 s[40:43], s[0:1], 56
    s_load_dwordx2 s[46:47], s[0:1], 80
    s_and_b32 s3, s2, 7
    s_lshr_b32 s4, s2, 3
    s_lshr_b32 s5, s3, 1
    s_lshl_b32 s5, s5, 3
    s_and_b32 s6, s4, 7
    s_add_u32 s50, s5, s6
    s_and_b32 s5, s3, 1
    s_lshl_b32 s5, s5, 2
    s_lshr_b32 s6, s4, 3
    s_add_u32 s51, s5, s6
    v_lshrrev_b32 v1, 6, v0
    s_nop 0
    v_readfirstlane_b32 s52, v1
    v_and_b32 v1, 63, v0
    v_and_b32 v2, 15, v1
    v_lshrrev_b32 v3, 4, v1
    v_lshlrev_b32 v4, 4, v1
    v_add_u32 v5, 0x1000, v4
    s_mul_i32 s53, s52, 9
    s_lshl_b32 s54, s52, 3
    s_add_u32 s54, s54, 4
    s_cmp_lt_u32 s52, 4
    s_cselect_b32 s53, s53, s54
    s_and_b32 s61, s4, 7
    s_mul_i32 s61, s61, 0
    s_lshr_b32 s62, s4, 3
    s_mul_i32 s62, s62, 0
    s_add_u32 s61, s61, s62
    s_add_u32 s53, s53, s61
    s_sub_u32 s61, s53, 68
    s_cmp_ge_u32 s53, 68
    s_cselect_b32 s53, s61, s53
    s_mul_i32 s62, s50, 278528
    s_lshl_b32 s55, s53, 12
    s_add_u32 s60, s62, s55
    s_add_u32 s63, s62, 278528
    s_mul_i32 s64, s51, 348160
    s_add_u32 s64, s64, 0x880000
    s_mul_i32 s56, s53, 5120
    s_add_u32 s56, s56, s64
    s_waitcnt lgkmcnt(0)
    s_mov_b32 s8, s36
    s_and_b32 s9, s37, 0xffff
    s_mov_b32 s10, 0x280000
    s_mov_b32 s11, 0x20000
    s_mov_b32 s12, s40
    s_and_b32 s13, s41, 0xffff
    s_mov_b32 s14, 0x500
    s_mov_b32 s15, 0x20000
    s_mov_b32 s20, s42
    s_and_b32 s21, s43, 0xffff
    s_mov_b32 s22, 0x280000
    s_mov_b32 s23, 0x20000
    s_mov_b32 s16, s46
    s_and_b32 s17, s47, 0xffff
    s_mov_b32 s18, 0xb28000
    s_mov_b32 s19, 0x20000
    buffer_load_dwordx4 v[36:39], v4, s[16:19], s56 offen offset:0
    buffer_load_dwordx4 v[40:43], v4, s[16:19], s56 offen offset:1024
    buffer_load_dwordx4 v[44:47], v4, s[16:19], s56 offen offset:2048
    buffer_load_dwordx4 v[48:51], v4, s[16:19], s56 offen offset:3072
    buffer_load_dwordx4 v[52:55], v5, s[16:19], s56 offen
    buffer_load_dwordx4 v[20:23], v4, s[16:19], s60 offen offset:0
    buffer_load_dwordx4 v[24:27], v4, s[16:19], s60 offen offset:1024
    buffer_load_dwordx4 v[28:31], v4, s[16:19], s60 offen offset:2048
    buffer_load_dwordx4 v[32:35], v4, s[16:19], s60 offen offset:3072
    s_add_u32 s56, s56, 5120
    s_add_u32 s60, s60, 4096
    s_cmp_eq_u32 s60, s63
    s_cselect_b32 s60, s62, s60
    s_cselect_b32 s56, s64, s56
    buffer_load_dwordx4 v[72:75], v4, s[16:19], s56 offen offset:0
    buffer_load_dwordx4 v[76:79], v4, s[16:19], s56 offen offset:1024
    buffer_load_dwordx4 v[80:83], v4, s[16:19], s56 offen offset:2048
    buffer_load_dwordx4 v[84:87], v4, s[16:19], s56 offen offset:3072
    buffer_load_dwordx4 v[88:91], v5, s[16:19], s56 offen
    buffer_load_dwordx4 v[56:59], v4, s[16:19], s60 offen offset:0
    buffer_load_dwordx4 v[60:63], v4, s[16:19], s60 offen offset:1024
    buffer_load_dwordx4 v[64:67], v4, s[16:19], s60 offen offset:2048
    buffer_load_dwordx4 v[68:71], v4, s[16:19], s60 offen offset:3072
    s_add_u32 s56, s56, 5120
    s_add_u32 s60, s60, 4096
    s_cmp_eq_u32 s60, s63
    s_cselect_b32 s60, s62, s60
    s_cselect_b32 s56, s64, s56
    buffer_load_dwordx4 v[108:111], v4, s[16:19], s56 offen offset:0
    buffer_load_dwordx4 v[112:115], v4, s[16:19], s56 offen offset:1024
    buffer_load_dwordx4 v[116:119], v4, s[16:19], s56 offen offset:2048
    buffer_load_dwordx4 v[120:123], v4, s[16:19], s56 offen offset:3072
    buffer_load_dwordx4 v[124:127], v5, s[16:19], s56 offen
    buffer_load_dwordx4 v[92:95], v4, s[16:19], s60 offen offset:0
    buffer_load_dwordx4 v[96:99], v4, s[16:19], s60 offen offset:1024
    buffer_load_dwordx4 v[100:103], v4, s[16:19], s60 offen offset:2048
    buffer_load_dwordx4 v[104:107], v4, s[16:19], s60 offen offset:3072
    s_add_u32 s56, s56, 5120
    s_add_u32 s60, s60, 4096
    s_cmp_eq_u32 s60, s63
    s_cselect_b32 s60, s62, s60
    s_cselect_b32 s56, s64, s56
    buffer_load_dwordx4 v[144:147], v4, s[16:19], s56 offen offset:0
    buffer_load_dwordx4 v[148:151], v4, s[16:19], s56 offen offset:1024
    buffer_load_dwordx4 v[152:155], v4, s[16:19], s56 offen offset:2048
    buffer_load_dwordx4 v[156:159], v4, s[16:19], s56 offen offset:3072
    buffer_load_dwordx4 v[160:163], v5, s[16:19], s56 offen
    buffer_load_dwordx4 v[128:131], v4, s[16:19], s60 offen offset:0
    buffer_load_dwordx4 v[132:135], v4, s[16:19], s60 offen offset:1024
    buffer_load_dwordx4 v[136:139], v4, s[16:19], s60 offen offset:2048
    buffer_load_dwordx4 v[140:143], v4, s[16:19], s60 offen offset:3072
    s_add_u32 s56, s56, 5120
    s_add_u32 s60, s60, 4096
    s_cmp_eq_u32 s60, s63
    s_cselect_b32 s60, s62, s60
    s_cselect_b32 s56, s64, s56
    s_waitcnt vmcnt(27)
    v_mfma_f32_16x16x32_bf16 a[0:3], v[36:39], v[20:23], 0
    v_mfma_f32_16x16x32_bf16 a[20:23], v[36:39], v[24:27], 0
    v_mfma_f32_16x16x32_bf16 a[40:43], v[36:39], v[28:31], 0
    v_mfma_f32_16x16x32_bf16 a[60:63], v[36:39], v[32:35], 0
    v_mfma_f32_16x16x32_bf16 a[4:7], v[40:43], v[20:23], 0
    v_mfma_f32_16x16x32_bf16 a[24:27], v[40:43], v[24:27], 0
    v_mfma_f32_16x16x32_bf16 a[44:47], v[40:43], v[28:31], 0
    v_mfma_f32_16x16x32_bf16 a[64:67], v[40:43], v[32:35], 0
    v_mfma_f32_16x16x32_bf16 a[8:11], v[44:47], v[20:23], 0
    v_mfma_f32_16x16x32_bf16 a[28:31], v[44:47], v[24:27], 0
    v_mfma_f32_16x16x32_bf16 a[48:51], v[44:47], v[28:31], 0
    v_mfma_f32_16x16x32_bf16 a[68:71], v[44:47], v[32:35], 0
    v_mfma_f32_16x16x32_bf16 a[12:15], v[48:51], v[20:23], 0
    v_mfma_f32_16x16x32_bf16 a[32:35], v[48:51], v[24:27], 0
    v_mfma_f32_16x16x32_bf16 a[52:55], v[48:51], v[28:31], 0
    v_mfma_f32_16x16x32_bf16 a[72:75], v[48:51], v[32:35], 0
    v_mfma_f32_16x16x32_bf16 a[16:19], v[52:55], v[20:23], 0
    v_mfma_f32_16x16x32_bf16 a[36:39], v[52:55], v[24:27], 0
    v_mfma_f32_16x16x32_bf16 a[56:59], v[52:55], v[28:31], 0
    v_mfma_f32_16x16x32_bf16 a[76:79], v[52:55], v[32:35], 0
    buffer_load_dwordx4 v[36:39], v4, s[16:19], s56 offen offset:0
    buffer_load_dwordx4 v[40:43], v4, s[16:19], s56 offen offset:1024
    buffer_load_dwordx4 v[44:47], v4, s[16:19], s56 offen offset:2048
    buffer_load_dwordx4 v[48:51], v4, s[16:19], s56 offen offset:3072
    buffer_load_dwordx4 v[52:55], v5, s[16:19], s56 offen
    buffer_load_dwordx4 v[20:23], v4, s[16:19], s60 offen offset:0
    buffer_load_dwordx4 v[24:27], v4, s[16:19], s60 offen offset:1024
    buffer_load_dwordx4 v[28:31], v4, s[16:19], s60 offen offset:2048
    buffer_load_dwordx4 v[32:35], v4, s[16:19], s60 offen offset:3072
    s_add_u32 s56, s56, 5120
    s_add_u32 s60, s60, 4096
    s_cmp_eq_u32 s60, s63
    s_cselect_b32 s60, s62, s60
    s_cselect_b32 s56, s64, s56
    s_waitcnt vmcnt(27)
    v_mfma_f32_16x16x32_bf16 a[0:3], v[72:75], v[56:59], a[0:3]
    v_mfma_f32_16x16x32_bf16 a[20:23], v[72:75], v[60:63], a[20:23]
    v_mfma_f32_16x16x32_bf16 a[40:43], v[72:75], v[64:67], a[40:43]
    v_mfma_f32_16x16x32_bf16 a[60:63], v[72:75], v[68:71], a[60:63]
    v_mfma_f32_16x16x32_bf16 a[4:7], v[76:79], v[56:59], a[4:7]
    v_mfma_f32_16x16x32_bf16 a[24:27], v[76:79], v[60:63], a[24:27]
    v_mfma_f32_16x16x32_bf16 a[44:47], v[76:79], v[64:67], a[44:47]
    v_mfma_f32_16x16x32_bf16 a[64:67], v[76:79], v[68:71], a[64:67]
    v_mfma_f32_16x16x32_bf16 a[8:11], v[80:83], v[56:59], a[8:11]
    v_mfma_f32_16x16x32_bf16 a[28:31], v[80:83], v[60:63], a[28:31]
    v_mfma_f32_16x16x32_bf16 a[48:51], v[80:83], v[64:67], a[48:51]
    v_mfma_f32_16x16x32_bf16 a[68:71], v[80:83], v[68:71], a[68:71]
    v_mfma_f32_16x16x32_bf16 a[12:15], v[84:87], v[56:59], a[12:15]
    v_mfma_f32_16x16x32_bf16 a[32:35], v[84:87], v[60:63], a[32:35]
    v_mfma_f32_16x16x32_bf16 a[52:55], v[84:87], v[64:67], a[52:55]
    v_mfma_f32_16x16x32_bf16 a[72:75], v[84:87], v[68:71], a[72:75]
    v_mfma_f32_16x16x32_bf16 a[16:19], v[88:91], v[56:59], a[16:19]
    v_mfma_f32_16x16x32_bf16 a[36:39], v[88:91], v[60:63], a[36:39]
    v_mfma_f32_16x16x32_bf16 a[56:59], v[88:91], v[64:67], a[56:59]
    v_mfma_f32_16x16x32_bf16 a[76:79], v[88:91], v[68:71], a[76:79]
    buffer_load_dwordx4 v[72:75], v4, s[16:19], s56 offen offset:0
    buffer_load_dwordx4 v[76:79], v4, s[16:19], s56 offen offset:1024
    buffer_load_dwordx4 v[80:83], v4, s[16:19], s56 offen offset:2048
    buffer_load_dwordx4 v[84:87], v4, s[16:19], s56 offen offset:3072
    buffer_load_dwordx4 v[88:91], v5, s[16:19], s56 offen
    buffer_load_dwordx4 v[56:59], v4, s[16:19], s60 offen offset:0
    buffer_load_dwordx4 v[60:63], v4, s[16:19], s60 offen offset:1024
    buffer_load_dwordx4 v[64:67], v4, s[16:19], s60 offen offset:2048
    buffer_load_dwordx4 v[68:71], v4, s[16:19], s60 offen offset:3072
    s_add_u32 s56, s56, 5120
    s_add_u32 s60, s60, 4096
    s_cmp_eq_u32 s60, s63
    s_cselect_b32 s60, s62, s60
    s_cselect_b32 s56, s64, s56
    s_waitcnt vmcnt(27)
    v_mfma_f32_16x16x32_bf16 a[0:3], v[108:111], v[92:95], a[0:3]
    v_mfma_f32_16x16x32_bf16 a[20:23], v[108:111], v[96:99], a[20:23]
    v_mfma_f32_16x16x32_bf16 a[40:43], v[108:111], v[100:103], a[40:43]
    v_mfma_f32_16x16x32_bf16 a[60:63], v[108:111], v[104:107], a[60:63]
    v_mfma_f32_16x16x32_bf16 a[4:7], v[112:115], v[92:95], a[4:7]
    v_mfma_f32_16x16x32_bf16 a[24:27], v[112:115], v[96:99], a[24:27]
    v_mfma_f32_16x16x32_bf16 a[44:47], v[112:115], v[100:103], a[44:47]
    v_mfma_f32_16x16x32_bf16 a[64:67], v[112:115], v[104:107], a[64:67]
    v_mfma_f32_16x16x32_bf16 a[8:11], v[116:119], v[92:95], a[8:11]
    v_mfma_f32_16x16x32_bf16 a[28:31], v[116:119], v[96:99], a[28:31]
    v_mfma_f32_16x16x32_bf16 a[48:51], v[116:119], v[100:103], a[48:51]
    v_mfma_f32_16x16x32_bf16 a[68:71], v[116:119], v[104:107], a[68:71]
    v_mfma_f32_16x16x32_bf16 a[12:15], v[120:123], v[92:95], a[12:15]
    v_mfma_f32_16x16x32_bf16 a[32:35], v[120:123], v[96:99], a[32:35]
    v_mfma_f32_16x16x32_bf16 a[52:55], v[120:123], v[100:103], a[52:55]
    v_mfma_f32_16x16x32_bf16 a[72:75], v[120:123], v[104:107], a[72:75]
    v_mfma_f32_16x16x32_bf16 a[16:19], v[124:127], v[92:95], a[16:19]
    v_mfma_f32_16x16x32_bf16 a[36:39], v[124:127], v[96:99], a[36:39]
    v_mfma_f32_16x16x32_bf16 a[56:59], v[124:127], v[100:103], a[56:59]
    v_mfma_f32_16x16x32_bf16 a[76:79], v[124:127], v[104:107], a[76:79]
    buffer_load_dwordx4 v[108:111], v4, s[16:19], s56 offen offset:0
    buffer_load_dwordx4 v[112:115], v4, s[16:19], s56 offen offset:1024
    buffer_load_dwordx4 v[116:119], v4, s[16:19], s56 offen offset:2048
    buffer_load_dwordx4 v[120:123], v4, s[16:19], s56 offen offset:3072
    buffer_load_dwordx4 v[124:127], v5, s[16:19], s56 offen
    buffer_load_dwordx4 v[92:95], v4, s[16:19], s60 offen offset:0
    buffer_load_dwordx4 v[96:99], v4, s[16:19], s60 offen offset:1024
    buffer_load_dwordx4 v[100:103], v4, s[16:19], s60 offen offset:2048
    buffer_load_dwordx4 v[104:107], v4, s[16:19], s60 offen offset:3072
    s_add_u32 s56, s56, 5120
    s_add_u32 s60, s60, 4096
    s_cmp_eq_u32 s60, s63
    s_cselect_b32 s60, s62, s60
    s_cselect_b32 s56, s64, s56
    s_waitcnt vmcnt(27)
    v_mfma_f32_16x16x32_bf16 a[0:3], v[144:147], v[128:131], a[0:3]
    v_mfma_f32_16x16x32_bf16 a[20:23], v[144:147], v[132:135], a[20:23]
    v_mfma_f32_16x16x32_bf16 a[40:43], v[144:147], v[136:139], a[40:43]
    v_mfma_f32_16x16x32_bf16 a[60:63], v[144:147], v[140:143], a[60:63]
    v_mfma_f32_16x16x32_bf16 a[4:7], v[148:151], v[128:131], a[4:7]
    v_mfma_f32_16x16x32_bf16 a[24:27], v[148:151], v[132:135], a[24:27]
    v_mfma_f32_16x16x32_bf16 a[44:47], v[148:151], v[136:139], a[44:47]
    v_mfma_f32_16x16x32_bf16 a[64:67], v[148:151], v[140:143], a[64:67]
    v_mfma_f32_16x16x32_bf16 a[8:11], v[152:155], v[128:131], a[8:11]
    v_mfma_f32_16x16x32_bf16 a[28:31], v[152:155], v[132:135], a[28:31]
    v_mfma_f32_16x16x32_bf16 a[48:51], v[152:155], v[136:139], a[48:51]
    v_mfma_f32_16x16x32_bf16 a[68:71], v[152:155], v[140:143], a[68:71]
    v_mfma_f32_16x16x32_bf16 a[12:15], v[156:159], v[128:131], a[12:15]
    v_mfma_f32_16x16x32_bf16 a[32:35], v[156:159], v[132:135], a[32:35]
    v_mfma_f32_16x16x32_bf16 a[52:55], v[156:159], v[136:139], a[52:55]
    v_mfma_f32_16x16x32_bf16 a[72:75], v[156:159], v[140:143], a[72:75]
    v_mfma_f32_16x16x32_bf16 a[16:19], v[160:163], v[128:131], a[16:19]
    v_mfma_f32_16x16x32_bf16 a[36:39], v[160:163], v[132:135], a[36:39]
    v_mfma_f32_16x16x32_bf16 a[56:59], v[160:163], v[136:139], a[56:59]
    v_mfma_f32_16x16x32_bf16 a[76:79], v[160:163], v[140:143], a[76:79]
    buffer_load_dwordx4 v[144:147], v4, s[16:19], s56 offen offset:0
    buffer_load_dwordx4 v[148:151], v4, s[16:19], s56 offen offset:1024
    buffer_load_dwordx4 v[152:155], v4, s[16:19], s56 offen offset:2048
    buffer_load_dwordx4 v[156:159], v4, s[16:19], s56 offen offset:3072
    buffer_load_dwordx4 v[160:163], v5, s[16:19], s56 offen
    buffer_load_dwordx4 v[128:131], v4, s[16:19], s60 offen offset:0
    buffer_load_dwordx4 v[132:135], v4, s[16:19], s60 offen offset:1024
    buffer_load_dwordx4 v[136:139], v4, s[16:19], s60 offen offset:2048
    buffer_load_dwordx4 v[140:143], v4, s[16:19], s60 offen offset:3072
    s_add_u32 s56, s56, 5120
    s_add_u32 s60, s60, 4096
    s_cmp_eq_u32 s60, s63
    s_cselect_b32 s60, s62, s60
    s_cselect_b32 s56, s64, s56
    s_waitcnt vmcnt(27)
    v_mfma_f32_16x16x32_bf16 a[0:3], v[36:39], v[20:23], a[0:3]
    v_mfma_f32_16x16x32_bf16 a[20:23], v[36:39], v[24:27], a[20:23]
    v_mfma_f32_16x16x32_bf16 a[40:43], v[36:39], v[28:31], a[40:43]
    v_mfma_f32_16x16x32_bf16 a[60:63], v[36:39], v[32:35], a[60:63]
    v_mfma_f32_16x16x32_bf16 a[4:7], v[40:43], v[20:23], a[4:7]
    v_mfma_f32_16x16x32_bf16 a[24:27], v[40:43], v[24:27], a[24:27]
    v_mfma_f32_16x16x32_bf16 a[44:47], v[40:43], v[28:31], a[44:47]
    v_mfma_f32_16x16x32_bf16 a[64:67], v[40:43], v[32:35], a[64:67]
    v_mfma_f32_16x16x32_bf16 a[8:11], v[44:47], v[20:23], a[8:11]
    v_mfma_f32_16x16x32_bf16 a[28:31], v[44:47], v[24:27], a[28:31]
    v_mfma_f32_16x16x32_bf16 a[48:51], v[44:47], v[28:31], a[48:51]
    v_mfma_f32_16x16x32_bf16 a[68:71], v[44:47], v[32:35], a[68:71]
    v_mfma_f32_16x16x32_bf16 a[12:15], v[48:51], v[20:23], a[12:15]
    v_mfma_f32_16x16x32_bf16 a[32:35], v[48:51], v[24:27], a[32:35]
    v_mfma_f32_16x16x32_bf16 a[52:55], v[48:51], v[28:31], a[52:55]
    v_mfma_f32_16x16x32_bf16 a[72:75], v[48:51], v[32:35], a[72:75]
    v_mfma_f32_16x16x32_bf16 a[16:19], v[52:55], v[20:23], a[16:19]
    v_mfma_f32_16x16x32_bf16 a[36:39], v[52:55], v[24:27], a[36:39]
    v_mfma_f32_16x16x32_bf16 a[56:59], v[52:55], v[28:31], a[56:59]
    v_mfma_f32_16x16x32_bf16 a[76:79], v[52:55], v[32:35], a[76:79]
    s_cmp_ge_u32 s52, 4
    s_cbranch_scc1 k2_skipl8
    buffer_load_dwordx4 v[36:39], v4, s[16:19], s56 offen offset:0
    buffer_load_dwordx4 v[40:43], v4, s[16:19], s56 offen offset:1024
    buffer_load_dwordx4 v[44:47], v4, s[16:19], s56 offen offset:2048
    buffer_load_dwordx4 v[48:51], v4, s[16:19], s56 offen offset:3072
    buffer_load_dwordx4 v[52:55], v5, s[16:19], s56 offen
    buffer_load_dwordx4 v[20:23], v4, s[16:19], s60 offen offset:0
    buffer_load_dwordx4 v[24:27], v4, s[16:19], s60 offen offset:1024
    buffer_load_dwordx4 v[28:31], v4, s[16:19], s60 offen offset:2048
    buffer_load_dwordx4 v[32:35], v4, s[16:19], s60 offen offset:3072
    s_add_u32 s56, s56, 5120
    s_add_u32 s60, s60, 4096
    s_cmp_eq_u32 s60, s63
    s_cselect_b32 s60, s62, s60
    s_cselect_b32 s56, s64, s56
k2_skipl8:
    s_waitcnt vmcnt(18)
    v_mfma_f32_16x16x32_bf16 a[0:3], v[72:75], v[56:59], a[0:3]
    v_mfma_f32_16x16x32_bf16 a[20:23], v[72:75], v[60:63], a[20:23]
    v_mfma_f32_16x16x32_bf16 a[40:43], v[72:75], v[64:67], a[40:43]
    v_mfma_f32_16x16x32_bf16 a[60:63], v[72:75], v[68:71], a[60:63]
    v_mfma_f32_16x16x32_bf16 a[4:7], v[76:79], v[56:59], a[4:7]
    v_mfma_f32_16x16x32_bf16 a[24:27], v[76:79], v[60:63], a[24:27]
    v_mfma_f32_16x16x32_bf16 a[44:47], v[76:79], v[64:67], a[44:47]
    v_mfma_f32_16x16x32_bf16 a[64:67], v[76:79], v[68:71], a[64:67]
    v_mfma_f32_16x16x32_bf16 a[8:11], v[80:83], v[56:59], a[8:11]
    v_mfma_f32_16x16x32_bf16 a[28:31], v[80:83], v[60:63], a[28:31]
    v_mfma_f32_16x16x32_bf16 a[48:51], v[80:83], v[64:67], a[48:51]
    v_mfma_f32_16x16x32_bf16 a[68:71], v[80:83], v[68:71], a[68:71]
    v_mfma_f32_16x16x32_bf16 a[12:15], v[84:87], v[56:59], a[12:15]
    v_mfma_f32_16x16x32_bf16 a[32:35], v[84:87], v[60:63], a[32:35]
    v_mfma_f32_16x16x32_bf16 a[52:55], v[84:87], v[64:67], a[52:55]
    v_mfma_f32_16x16x32_bf16 a[72:75], v[84:87], v[68:71], a[72:75]
    v_mfma_f32_16x16x32_bf16 a[16:19], v[88:91], v[56:59], a[16:19]
    v_mfma_f32_16x16x32_bf16 a[36:39], v[88:91], v[60:63], a[36:39]
    v_mfma_f32_16x16x32_bf16 a[56:59], v[88:91], v[64:67], a[56:59]
    v_mfma_f32_16x16x32_bf16 a[76:79], v[88:91], v[68:71], a[76:79]
    s_waitcnt vmcnt(9)
    v_mfma_f32_16x16x32_bf16 a[0:3], v[108:111], v[92:95], a[0:3]
    v_mfma_f32_16x16x32_bf16 a[20:23], v[108:111], v[96:99], a[20:23]
    v_mfma_f32_16x16x32_bf16 a[40:43], v[108:111], v[100:103], a[40:43]
    v_mfma_f32_16x16x32_bf16 a[60:63], v[108:111], v[104:107], a[60:63]
    v_mfma_f32_16x16x32_bf16 a[4:7], v[112:115], v[92:95], a[4:7]
    v_mfma_f32_16x16x32_bf16 a[24:27], v[112:115], v[96:99], a[24:27]
    v_mfma_f32_16x16x32_bf16 a[44:47], v[112:115], v[100:103], a[44:47]
    v_mfma_f32_16x16x32_bf16 a[64:67], v[112:115], v[104:107], a[64:67]
    v_mfma_f32_16x16x32_bf16 a[8:11], v[116:119], v[92:95], a[8:11]
    v_mfma_f32_16x16x32_bf16 a[28:31], v[116:119], v[96:99], a[28:31]
    v_mfma_f32_16x16x32_bf16 a[48:51], v[116:119], v[100:103], a[48:51]
    v_mfma_f32_16x16x32_bf16 a[68:71], v[116:119], v[104:107], a[68:71]
    v_mfma_f32_16x16x32_bf16 a[12:15], v[120:123], v[92:95], a[12:15]
    v_mfma_f32_16x16x32_bf16 a[32:35], v[120:123], v[96:99], a[32:35]
    v_mfma_f32_16x16x32_bf16 a[52:55], v[120:123], v[100:103], a[52:55]
    v_mfma_f32_16x16x32_bf16 a[72:75], v[120:123], v[104:107], a[72:75]
    v_mfma_f32_16x16x32_bf16 a[16:19], v[124:127], v[92:95], a[16:19]
    v_mfma_f32_16x16x32_bf16 a[36:39], v[124:127], v[96:99], a[36:39]
    v_mfma_f32_16x16x32_bf16 a[56:59], v[124:127], v[100:103], a[56:59]
    v_mfma_f32_16x16x32_bf16 a[76:79], v[124:127], v[104:107], a[76:79]
    s_waitcnt vmcnt(0)
    v_mfma_f32_16x16x32_bf16 a[0:3], v[144:147], v[128:131], a[0:3]
    v_mfma_f32_16x16x32_bf16 a[20:23], v[144:147], v[132:135], a[20:23]
    v_mfma_f32_16x16x32_bf16 a[40:43], v[144:147], v[136:139], a[40:43]
    v_mfma_f32_16x16x32_bf16 a[60:63], v[144:147], v[140:143], a[60:63]
    v_mfma_f32_16x16x32_bf16 a[4:7], v[148:151], v[128:131], a[4:7]
    v_mfma_f32_16x16x32_bf16 a[24:27], v[148:151], v[132:135], a[24:27]
    v_mfma_f32_16x16x32_bf16 a[44:47], v[148:151], v[136:139], a[44:47]
    v_mfma_f32_16x16x32_bf16 a[64:67], v[148:151], v[140:143], a[64:67]
    v_mfma_f32_16x16x32_bf16 a[8:11], v[152:155], v[128:131], a[8:11]
    v_mfma_f32_16x16x32_bf16 a[28:31], v[152:155], v[132:135], a[28:31]
    v_mfma_f32_16x16x32_bf16 a[48:51], v[152:155], v[136:139], a[48:51]
    v_mfma_f32_16x16x32_bf16 a[68:71], v[152:155], v[140:143], a[68:71]
    v_mfma_f32_16x16x32_bf16 a[12:15], v[156:159], v[128:131], a[12:15]
    v_mfma_f32_16x16x32_bf16 a[32:35], v[156:159], v[132:135], a[32:35]
    v_mfma_f32_16x16x32_bf16 a[52:55], v[156:159], v[136:139], a[52:55]
    v_mfma_f32_16x16x32_bf16 a[72:75], v[156:159], v[140:143], a[72:75]
    v_mfma_f32_16x16x32_bf16 a[16:19], v[160:163], v[128:131], a[16:19]
    v_mfma_f32_16x16x32_bf16 a[36:39], v[160:163], v[132:135], a[36:39]
    v_mfma_f32_16x16x32_bf16 a[56:59], v[160:163], v[136:139], a[56:59]
    v_mfma_f32_16x16x32_bf16 a[76:79], v[160:163], v[140:143], a[76:79]
    s_cmp_ge_u32 s52, 4
    s_cbranch_scc1 k2_skip8
    s_waitcnt vmcnt(0)
    v_mfma_f32_16x16x32_bf16 a[0:3], v[36:39], v[20:23], a[0:3]
    v_mfma_f32_16x16x32_bf16 a[20:23], v[36:39], v[24:27], a[20:23]
    v_mfma_f32_16x16x32_bf16 a[40:43], v[36:39], v[28:31], a[40:43]
    v_mfma_f32_16x16x32_bf16 a[60:63], v[36:39], v[32:35], a[60:63]
    v_mfma_f32_16x16x32_bf16 a[4:7], v[40:43], v[20:23], a[4:7]
    v_mfma_f32_16x16x32_bf16 a[24:27], v[40:43], v[24:27], a[24:27]
    v_mfma_f32_16x16x32_bf16 a[44:47], v[40:43], v[28:31], a[44:47]
    v_mfma_f32_16x16x32_bf16 a[64:67], v[40:43], v[32:35], a[64:67]
    v_mfma_f32_16x16x32_bf16 a[8:11], v[44:47], v[20:23], a[8:11]
    v_mfma_f32_16x16x32_bf16 a[28:31], v[44:47], v[24:27], a[28:31]
    v_mfma_f32_16x16x32_bf16 a[48:51], v[44:47], v[28:31], a[48:51]
    v_mfma_f32_16x16x32_bf16 a[68:71], v[44:47], v[32:35], a[68:71]
    v_mfma_f32_16x16x32_bf16 a[12:15], v[48:51], v[20:23], a[12:15]
    v_mfma_f32_16x16x32_bf16 a[32:35], v[48:51], v[24:27], a[32:35]
    v_mfma_f32_16x16x32_bf16 a[52:55], v[48:51], v[28:31], a[52:55]
    v_mfma_f32_16x16x32_bf16 a[72:75], v[48:51], v[32:35], a[72:75]
    v_mfma_f32_16x16x32_bf16 a[16:19], v[52:55], v[20:23], a[16:19]
    v_mfma_f32_16x16x32_bf16 a[36:39], v[52:55], v[24:27], a[36:39]
    v_mfma_f32_16x16x32_bf16 a[56:59], v[52:55], v[28:31], a[56:59]
    v_mfma_f32_16x16x32_bf16 a[76:79], v[52:55], v[32:35], a[76:79]
k2_skip8:
    s_and_b32 s55, s52, 3
    s_lshl_b32 s53, s50, 6
    s_lshl_b32 s54, s55, 4
    s_add_u32 s53, s53, s54
    v_add_u32 v15, s53, v2
    v_mul_u32_u24 v15, 1280, v15
    s_mul_i32 s53, s51, 160
    s_lshr_b32 s54, s52, 2
    s_mul_i32 s54, s54, 96
    s_add_u32 s53, s53, s54
    v_lshl_add_u32 v16, v3, 3, s53
    v_add_u32 v15, v15, v16
    buffer_load_dwordx2 v[164:165], v15, s[8:11], 0 offen offset:0
    buffer_load_dwordx2 v[170:171], v16, s[12:15], 0 offen offset:0
    buffer_load_dwordx2 v[166:167], v15, s[8:11], 0 offen offset:32
    buffer_load_dwordx2 v[172:173], v16, s[12:15], 0 offen offset:32
    buffer_load_dwordx2 v[168:169], v15, s[8:11], 0 offen offset:64
    buffer_load_dwordx2 v[174:175], v16, s[12:15], 0 offen offset:64
    s_nop 7
    s_mul_i32 s53, s52, 20480
    v_add_u32 v18, s53, v4
    ds_write_b128 v18, a[0:3] offset:0
    ds_write_b128 v18, a[4:7] offset:1024
    ds_write_b128 v18, a[8:11] offset:2048
    ds_write_b128 v18, a[12:15] offset:3072
    ds_write_b128 v18, a[16:19] offset:4096
    ds_write_b128 v18, a[20:23] offset:5120
    ds_write_b128 v18, a[24:27] offset:6144
    ds_write_b128 v18, a[28:31] offset:7168
    ds_write_b128 v18, a[32:35] offset:8192
    ds_write_b128 v18, a[36:39] offset:9216
    ds_write_b128 v18, a[40:43] offset:10240
    ds_write_b128 v18, a[44:47] offset:11264
    ds_write_b128 v18, a[48:51] offset:12288
    ds_write_b128 v18, a[52:55] offset:13312
    ds_write_b128 v18, a[56:59] offset:14336
    ds_write_b128 v18, a[60:63] offset:15360
    ds_write_b128 v18, a[64:67] offset:16384
    ds_write_b128 v18, a[68:71] offset:17408
    ds_write_b128 v18, a[72:75] offset:18432
    ds_write_b128 v18, a[76:79] offset:19456
    s_waitcnt lgkmcnt(0)
    s_barrier
    s_mul_i32 s53, s55, 5120
    s_lshr_b32 s54, s52, 2
    s_mul_i32 s54, s54, 3072
    s_add_u32 s53, s53, s54
    v_add_u32 v18, s53, v4
    v_add_u32 v17, 0xf000, v18
    v_add_u32 v19, 0x1e000, v18
    ds_read_b128 v[20:23], v18 offset:0
    ds_read_b128 v[24:27], v18 offset:20480
    ds_read_b128 v[28:31], v18 offset:40960
    ds_read_b128 v[32:35], v17 offset:0
    ds_read_b128 v[36:39], v17 offset:20480
    ds_read_b128 v[40:43], v17 offset:40960
    ds_read_b128 v[44:47], v19 offset:0
    ds_read_b128 v[48:51], v19 offset:20480
    ds_read_b128 v[52:55], v18 offset:1024
    ds_read_b128 v[56:59], v18 offset:21504
    ds_read_b128 v[60:63], v18 offset:41984
    ds_read_b128 v[64:67], v17 offset:1024
    ds_read_b128 v[68:71], v17 offset:21504
    ds_read_b128 v[72:75], v17 offset:41984
    ds_read_b128 v[76:79], v19 offset:1024
    ds_read_b128 v[80:83], v19 offset:21504
    s_cmp_ge_u32 s52, 4
    s_cbranch_scc1 k2_rd2
    ds_read_b128 v[84:87], v18 offset:2048
    ds_read_b128 v[88:91], v18 offset:22528
    ds_read_b128 v[92:95], v18 offset:43008
    ds_read_b128 v[96:99], v17 offset:2048
    ds_read_b128 v[100:103], v17 offset:22528
    ds_read_b128 v[104:107], v17 offset:43008
    ds_read_b128 v[108:111], v19 offset:2048
    ds_read_b128 v[112:115], v19 offset:22528
k2_rd2:
    s_waitcnt vmcnt(0) lgkmcnt(0)
    v_add_f32 v20, v20, v36
    v_add_f32 v21, v21, v37
    v_add_f32 v22, v22, v38
    v_add_f32 v23, v23, v39
    v_add_f32 v24, v24, v40
    v_add_f32 v25, v25, v41
    v_add_f32 v26, v26, v42
    v_add_f32 v27, v27, v43
    v_add_f32 v28, v28, v44
    v_add_f32 v29, v29, v45
    v_add_f32 v30, v30, v46
    v_add_f32 v31, v31, v47
    v_add_f32 v32, v32, v48
    v_add_f32 v33, v33, v49
    v_add_f32 v34, v34, v50
    v_add_f32 v35, v35, v51
    v_add_f32 v20, v20, v28
    v_add_f32 v21, v21, v29
    v_add_f32 v22, v22, v30
    v_add_f32 v23, v23, v31
    v_add_f32 v24, v24, v32
    v_add_f32 v25, v25, v33
    v_add_f32 v26, v26, v34
    v_add_f32 v27, v27, v35
    v_add_f32 v20, v20, v24
    v_add_f32 v21, v21, v25
    v_add_f32 v22, v22, v26
    v_add_f32 v23, v23, v27
    v_lshlrev_b32 v17, 16, v164
    v_lshlrev_b32 v19, 16, v170
    v_add_f32 v20, v20, v19
    v_add_f32 v20, v20, v17
    v_and_b32 v17, 0xffff0000, v164
    v_and_b32 v19, 0xffff0000, v170
    v_add_f32 v21, v21, v19
    v_add_f32 v21, v21, v17
    v_lshlrev_b32 v17, 16, v165
    v_lshlrev_b32 v19, 16, v171
    v_add_f32 v22, v22, v19
    v_add_f32 v22, v22, v17
    v_and_b32 v17, 0xffff0000, v165
    v_and_b32 v19, 0xffff0000, v171
    v_add_f32 v23, v23, v19
    v_add_f32 v23, v23, v17
    v_cvt_pk_bf16_f32 v20, v20, v21
    v_cvt_pk_bf16_f32 v21, v22, v23
    buffer_store_dwordx2 v[20:21], v15, s[20:23], 0 offen offset:0 sc1
    v_add_f32 v52, v52, v68
    v_add_f32 v53, v53, v69
    v_add_f32 v54, v54, v70
    v_add_f32 v55, v55, v71
    v_add_f32 v56, v56, v72
    v_add_f32 v57, v57, v73
    v_add_f32 v58, v58, v74
    v_add_f32 v59, v59, v75
    v_add_f32 v60, v60, v76
    v_add_f32 v61, v61, v77
    v_add_f32 v62, v62, v78
    v_add_f32 v63, v63, v79
    v_add_f32 v64, v64, v80
    v_add_f32 v65, v65, v81
    v_add_f32 v66, v66, v82
    v_add_f32 v67, v67, v83
    v_add_f32 v52, v52, v60
    v_add_f32 v53, v53, v61
    v_add_f32 v54, v54, v62
    v_add_f32 v55, v55, v63
    v_add_f32 v56, v56, v64
    v_add_f32 v57, v57, v65
    v_add_f32 v58, v58, v66
    v_add_f32 v59, v59, v67
    v_add_f32 v52, v52, v56
    v_add_f32 v53, v53, v57
    v_add_f32 v54, v54, v58
    v_add_f32 v55, v55, v59
    v_lshlrev_b32 v17, 16, v166
    v_lshlrev_b32 v19, 16, v172
    v_add_f32 v52, v52, v19
    v_add_f32 v52, v52, v17
    v_and_b32 v17, 0xffff0000, v166
    v_and_b32 v19, 0xffff0000, v172
    v_add_f32 v53, v53, v19
    v_add_f32 v53, v53, v17
    v_lshlrev_b32 v17, 16, v167
    v_lshlrev_b32 v19, 16, v173
    v_add_f32 v54, v54, v19
    v_add_f32 v54, v54, v17
    v_and_b32 v17, 0xffff0000, v167
    v_and_b32 v19, 0xffff0000, v173
    v_add_f32 v55, v55, v19
    v_add_f32 v55, v55, v17
    v_cvt_pk_bf16_f32 v52, v52, v53
    v_cvt_pk_bf16_f32 v53, v54, v55
    buffer_store_dwordx2 v[52:53], v15, s[20:23], 0 offen offset:32 sc1
    s_cmp_ge_u32 s52, 4
    s_cbranch_scc1 k2_fin
    v_add_f32 v84, v84, v100
    v_add_f32 v85, v85, v101
    v_add_f32 v86, v86, v102
    v_add_f32 v87, v87, v103
    v_add_f32 v88, v88, v104
    v_add_f32 v89, v89, v105
    v_add_f32 v90, v90, v106
    v_add_f32 v91, v91, v107
    v_add_f32 v92, v92, v108
    v_add_f32 v93, v93, v109
    v_add_f32 v94, v94, v110
    v_add_f32 v95, v95, v111
    v_add_f32 v96, v96, v112
    v_add_f32 v97, v97, v113
    v_add_f32 v98, v98, v114
    v_add_f32 v99, v99, v115
    v_add_f32 v84, v84, v92
    v_add_f32 v85, v85, v93
    v_add_f32 v86, v86, v94
    v_add_f32 v87, v87, v95
    v_add_f32 v88, v88, v96
    v_add_f32 v89, v89, v97
    v_add_f32 v90, v90, v98
    v_add_f32 v91, v91, v99
    v_add_f32 v84, v84, v88
    v_add_f32 v85, v85, v89
    v_add_f32 v86, v86, v90
    v_add_f32 v87, v87, v91
    v_lshlrev_b32 v17, 16, v168
    v_lshlrev_b32 v19, 16, v174
    v_add_f32 v84, v84, v19
    v_add_f32 v84, v84, v17
    v_and_b32 v17, 0xffff0000, v168
    v_and_b32 v19, 0xffff0000, v174
    v_add_f32 v85, v85, v19
    v_add_f32 v85, v85, v17
    v_lshlrev_b32 v17, 16, v169
    v_lshlrev_b32 v19, 16, v175
    v_add_f32 v86, v86, v19
    v_add_f32 v86, v86, v17
    v_and_b32 v17, 0xffff0000, v169
    v_and_b32 v19, 0xffff0000, v175
    v_add_f32 v87, v87, v19
    v_add_f32 v87, v87, v17
    v_cvt_pk_bf16_f32 v84, v84, v85
    v_cvt_pk_bf16_f32 v85, v86, v87
    buffer_store_dwordx2 v[84:85], v15, s[20:23], 0 offen offset:64 sc1
k2_fin:
k2_end:
    s_endpgm
.section .rodata,"a"
.p2align 6
.amdhsa_kernel k1_kernel
  .amdhsa_next_free_vgpr 168
  .amdhsa_next_free_sgpr 102
  .amdhsa_accum_offset 168
  .amdhsa_group_segment_fixed_size 0
  .amdhsa_kernarg_size 88
  .amdhsa_user_sgpr_count 2
  .amdhsa_user_sgpr_kernarg_segment_ptr 1
  .amdhsa_system_sgpr_workgroup_id_x 1
  .amdhsa_float_denorm_mode_32 3
.end_amdhsa_kernel
.p2align 6
.amdhsa_kernel k2_kernel
  .amdhsa_next_free_vgpr 256
  .amdhsa_next_free_sgpr 102
  .amdhsa_accum_offset 176
  .amdhsa_group_segment_fixed_size 0
  .amdhsa_kernarg_size 88
  .amdhsa_user_sgpr_count 2
  .amdhsa_user_sgpr_kernarg_segment_ptr 1
  .amdhsa_system_sgpr_workgroup_id_x 1
  .amdhsa_float_denorm_mode_32 3
.end_amdhsa_kernel
```
